```python
import torch

def _softmax(x, axis=-1):
    return torch.softmax(x, dim=axis)
def _gelu(x):
    return torch.nn.functional.gelu(x, approximate="tanh")
def _silu(x):
    return torch.nn.functional.silu(x)
def _sigmoid(x):
    return torch.sigmoid(x)
def _layernorm(x, axis=-1, eps=1e-5):
    m = x.mean(dim=axis, keepdim=True)
    v = x.var(dim=axis, keepdim=True, unbiased=False)
    return (x - m) / torch.sqrt(v + eps)
def _scatter_add(tgt, idx, src, axis=0):
    return tgt.clone().index_add_(axis, idx, src)
def _segment_sum(src, seg, n):
    out = torch.zeros((n,) + src.shape[1:], dtype=src.dtype)
    return out.index_add_(0, seg, src)
def _pad(x, pw):
    flat = tuple(v for pair in reversed(pw) for v in pair)
    return torch.nn.functional.pad(x, flat)

kernel_name = 'recurrent_scan__gqa_block_cached__glu_gated_swiglu__decode'

def setup_inputs():

    _w = (lambda a: (lambda t: t.to(torch.bfloat16) if t.is_floating_point() else t)(torch.as_tensor(a)))
    def _A_setup():
        B, Sq, D = 4, 1, 512
        Hq, Hkv, Sk, Dh = 32, 8, 4096, 128
        assert Hq % Hkv == 0, (Hq, Hkv)
        return {
            "x": _w((lambda *s: torch.randn(*s, dtype=torch.bfloat16) * 0.05)(B, Sq, D)),
            "k_cache": _w((lambda *s: torch.randn(*s, dtype=torch.bfloat16) * 3.2)(B, Hkv, Sk, Dh)),
            "v_cache": _w((lambda *s: torch.randn(*s, dtype=torch.bfloat16) * 3.2)(B, Hkv, Sk, Dh)),
            "wq": _w((lambda *s: torch.randn(*s, dtype=torch.bfloat16) * 3.2)(D, Hq * Dh) * (D ** -0.5)),
            "wo": _w((lambda *s: torch.randn(*s, dtype=torch.bfloat16) * 3.2)(Hq * Dh, D) * ((Hq * Dh) ** -0.5)),
        }
    _A_in = _A_setup()

    def _B_setup():
        B, S, D, F = 4, 1, 512, 1792
        return {
            "x": _w((lambda *s: torch.randn(*s, dtype=torch.bfloat16) * 0.05)(B, S, D)),
            "w1": _w((lambda *s: torch.randn(*s, dtype=torch.bfloat16) * 0.4)(D, F) * (2.0 / D) ** 0.5),
            "w3": _w((lambda *s: torch.randn(*s, dtype=torch.bfloat16) * 0.4)(D, F) * (2.0 / D) ** 0.5),
            "w2": _w((lambda *s: torch.randn(*s, dtype=torch.bfloat16) * 0.4)(F, D) * (2.0 / F) ** 0.5),
        }
    _B_in = _B_setup()

    return {
        "A_x": _A_in["x"],
        "A_k_cache": _A_in["k_cache"],
        "A_v_cache": _A_in["v_cache"],
        "A_wq": _A_in["wq"],
        "A_wo": _A_in["wo"],
        "B_x": _B_in["x"],
        "B_w1": _B_in["w1"],
        "B_w3": _B_in["w3"],
        "B_w2": _B_in["w2"],
    }

def reference(A_x, A_k_cache, A_v_cache, A_wq, A_wo, B_x, B_w1, B_w3, B_w2):
    def _A_ref(x, k_cache, v_cache, wq, wo):
        B, Sq, D = x.shape
        Hq, Dh = 32, 128
        Hkv = k_cache.shape[1]
        rep = Hq // Hkv
        q = (lambda x, *d: x.permute(*d))((x @ wq).reshape(B, Sq, Hq, Dh), 0, 2, 1, 3)
        k = (lambda x, n, axis: torch.repeat_interleave(x, n, dim=axis))(k_cache, rep, axis=1)
        v = (lambda x, n, axis: torch.repeat_interleave(x, n, dim=axis))(v_cache, rep, axis=1)
        scores = torch.einsum("bhqd,bhkd->bhqk", q, k) * (Dh ** -0.5)
        p = _softmax(scores, axis=-1)
        o = torch.einsum("bhqk,bhkd->bhqd", p, v)
        return (lambda x, *d: x.permute(*d))(o, 0, 2, 1, 3).reshape(B, Sq, Hq * Dh) @ wo

    def _B_ref(x, w1, w3, w2):
        gate = torch.einsum("bsd,df->bsf", x, w1)
        up = torch.einsum("bsd,df->bsf", x, w3)
        h = _silu(gate) * up
        out = torch.einsum("bsf,fd->bsd", h, w2)
        return out

    x = A_x
    xn = _layernorm(x, axis=-1)
    s = _A_ref(xn, A_k_cache, A_v_cache, A_wq, A_wo)
    g = _silu(_B_ref(xn, B_w1, B_w3, B_w2))
    return x + s * g
```

```asm
; @launch grid=(256,1,1) block=(512,1,1) lds=163840
.amdgcn_target "amdgcn-amd-amdhsa--gfx950"
.text
.globl recurrent_scan__gqa_block_cached__glu_gated_swiglu__decode_kernel
.p2align 8
.type recurrent_scan__gqa_block_cached__glu_gated_swiglu__decode_kernel,@function
recurrent_scan__gqa_block_cached__glu_gated_swiglu__decode_kernel:
    s_cmp_ge_u32 s2, 256
    s_cbranch_scc1 L_end
    s_load_dwordx2 s[40:41], s[0:1], 0
    s_load_dwordx2 s[4:5], s[0:1], 8
    s_load_dwordx2 s[12:13], s[0:1], 24
    s_load_dwordx2 s[56:57], s[0:1], 48
    s_load_dwordx2 s[24:25], s[0:1], 56
    s_load_dwordx2 s[36:37], s[0:1], 88
    v_and_b32 v1, 63, v0
    v_lshrrev_b32 v16, 6, v0
    s_and_b32 s26, s2, 7
    s_lshl_b32 s26, s26, 2
    s_lshr_b32 s26, 0x43206715, s26
    s_and_b32 s26, s26, 7
    v_readfirstlane_b32 s3, v16
    s_lshr_b32 s27, s2, 3
    s_and_b32 s44, s27, 7
    s_and_b32 s45, s27, 24
    s_add_u32 s45, s45, s26
    s_getreg_b32 s101, hwreg(HW_REG_XCC_ID, 0, 16)
    s_mov_b32 s42, 4096
    s_mov_b32 s43, 0x20000
    s_mov_b32 s6, 0x2000000
    s_mov_b32 s7, 0x20000
    s_mov_b32 s15, 0x20000
    s_mov_b32 s38, 0x1000000
    s_mov_b32 s39, 0x20000
    v_lshlrev_b32 v6, 4, v1
    v_lshrrev_b32 v16, 4, v1
    v_and_b32 v17, 15, v1
    v_lshlrev_b32 v18, 2, v16
    v_xor_b32 v18, v17, v18
    v_lshlrev_b32 v18, 4, v18
    v_lshl_add_u32 v2, v16, 8, v18
    v_xor_b32 v3, 16, v2
    v_xor_b32 v4, 32, v2
    v_xor_b32 v5, 48, v2
    s_xor_b32 s48, s45, 0
    s_lshl_b32 s48, s48, 20
    s_lshl_b32 s50, s44, 10
    s_add_u32 s48, s48, s50
    s_lshl_b32 s51, s3, 13
    s_add_u32 s48, s48, s51
    s_lshl_b32 s49, s3, 14
    s_bfe_u32 s55, s27, 0x10003
    s_add_u32 s50, s27, 1
    s_and_b32 s50, s50, 7
    s_lshl_b32 s51, s50, 7
    s_lshl_b32 s52, s26, 10
    s_add_u32 s51, s51, s52
    s_lshl_b32 s52, s55, 21
    s_add_u32 s51, s51, s52
    s_lshl_b32 s98, s50, 9
    s_lshl_b32 s52, s26, 13
    s_add_u32 s98, s98, s52
    s_lshl_b32 s52, s55, 12
    s_add_u32 s98, s98, s52
    s_add_u32 s98, s98, 65536
    s_mov_b32 s52, 8192
    s_mov_b32 s14, 0x400000
    s_mov_b32 s95, 65536
    s_lshl_b32 s58, s26, 2
    s_mul_i32 s59, s26, 3
    s_add_u32 s59, s59, 4
    s_cmp_lt_u32 s26, 4
    s_cselect_b32 s94, s58, s59
    s_cselect_b32 s59, 4, 3
    s_bitcmp1_b32 s27, 4
    s_cbranch_scc0 L_tileq
    s_add_u32 s50, s27, 3
    s_and_b32 s50, s50, 3
    s_cmp_lt_u32 s50, s59
    s_cselect_b32 s14, 0x1c0000, 0
    s_add_u32 s50, s50, s94
    s_lshl_b32 s51, s50, 7
    s_mul_i32 s52, s55, 917504
    s_add_u32 s51, s51, s52
    s_lshl_b32 s98, s50, 9
    s_bfe_u32 s50, s27, 0x10002
    s_mul_i32 s50, s50, 114688
    s_add_u32 s98, s98, s50
    s_mul_i32 s50, s55, 14336
    s_add_u32 s98, s98, s50
    s_add_u32 s98, s98, 327680
    s_mov_b32 s52, 3584
    s_mov_b32 s95, 28672
L_tileq:
    s_lshl_b32 s50, s3, 7
    s_add_u32 s98, s98, s50
    s_mul_i32 s50, s52, s3
    s_lshl_b32 s50, s50, 5
    s_add_u32 s51, s51, s50
    v_lshrrev_b32 v18, 3, v1
    v_mul_u32_u24 v20, s52, v18
    v_and_b32 v18, 7, v1
    v_bfe_u32 v19, v1, 4, 1
    v_lshlrev_b32 v19, 1, v19
    v_xor_b32 v18, v18, v19
    v_lshl_add_u32 v20, v18, 4, v20
    v_xor_b32 v21, 64, v20
    s_lshl_b32 s52, s52, 3
    s_lshl_b32 s53, s3, 10
    s_lshl_b32 s54, s3, 12
    s_add_u32 s54, s54, 131072
    s_and_b32 s101, s101, 0xff
    s_waitcnt lgkmcnt(0)
    s_bitcmp1_b32 s27, 4
    s_cbranch_scc0 L_tileq2
    s_bitcmp1_b32 s27, 2
    s_cselect_b32 s12, s24, s56
    s_cselect_b32 s13, s25, s57
L_tileq2:
    s_mov_b32 s99, s14
    s_cmp_ge_u32 s3, 4
    s_cbranch_scc1 L_nox
    buffer_load_dwordx4 v[24:27], v6, s[40:43], s53 offen
L_nox:
    s_add_u32 m0, s54, 0
    s_nop 0
    buffer_load_dwordx4 v20, s[12:15], s51 offen nt lds
    s_add_u32 s51, s51, s52
    s_add_u32 m0, s54, 1024
    s_nop 0
    buffer_load_dwordx4 v21, s[12:15], s51 offen nt lds
    s_add_u32 s51, s51, s52
    s_add_u32 m0, s54, 2048
    s_nop 0
    buffer_load_dwordx4 v20, s[12:15], s51 offen nt lds
    s_add_u32 s51, s51, s52
    s_add_u32 m0, s54, 3072
    s_nop 0
    buffer_load_dwordx4 v21, s[12:15], s51 offen nt lds
    s_add_u32 m0, s49, 0
    s_add_u32 s50, s48, 0
    buffer_load_dwordx4 v2, s[4:7], s50 offen nt lds
    s_add_u32 m0, s49, 1024
    s_xor_b32 s50, s48, 2048
    s_add_u32 s50, s50, 65536
    buffer_load_dwordx4 v3, s[4:7], s50 offen nt lds
    s_add_u32 m0, s49, 2048
    s_add_u32 s50, s48, 131072
    buffer_load_dwordx4 v4, s[4:7], s50 offen nt lds
    s_add_u32 m0, s49, 3072
    s_xor_b32 s50, s48, 2048
    s_add_u32 s50, s50, 196608
    buffer_load_dwordx4 v5, s[4:7], s50 offen nt lds
    s_add_u32 m0, s49, 4096
    s_add_u32 s50, s48, 262144
    buffer_load_dwordx4 v2, s[4:7], s50 offen nt lds
    s_add_u32 m0, s49, 5120
    s_xor_b32 s50, s48, 2048
    s_add_u32 s50, s50, 327680
    buffer_load_dwordx4 v3, s[4:7], s50 offen nt lds
    s_add_u32 m0, s49, 6144
    s_add_u32 s50, s48, 393216
    buffer_load_dwordx4 v4, s[4:7], s50 offen nt lds
    s_add_u32 m0, s49, 7168
    s_xor_b32 s50, s48, 2048
    s_add_u32 s50, s50, 458752
    buffer_load_dwordx4 v5, s[4:7], s50 offen nt lds
    s_load_dwordx2 s[8:9], s[0:1], 16
    s_load_dwordx2 s[16:17], s[0:1], 32
    s_load_dword s47, s[36:37], 0
    s_load_dwordx2 s[28:29], s[0:1], 64
    s_load_dwordx2 s[32:33], s[0:1], 72
    s_mov_b32 s10, 0x2000000
    s_mov_b32 s11, 0x20000
    s_mov_b32 s18, 0x400000
    s_mov_b32 s19, 0x20000
    s_mov_b32 s30, 0x1c0000
    s_mov_b32 s31, 0x20000
    s_mov_b32 s34, 4096
    s_mov_b32 s35, 0x20000
    v_mov_b32 v128, 0
    v_mov_b32 v129, 0
    v_mov_b32 v132, 0
    v_mov_b32 v133, 0
    v_mov_b32 v136, 0
    v_mov_b32 v137, 0
    v_mov_b32 v140, 0
    v_mov_b32 v141, 0
    v_mov_b32 v144, 0
    v_mov_b32 v145, 0
    v_mov_b32 v148, 0
    v_mov_b32 v149, 0
    v_mov_b32 v152, 0
    v_mov_b32 v153, 0
    v_mov_b32 v156, 0
    v_mov_b32 v157, 0
    v_mov_b32 v160, 0
    v_mov_b32 v161, 0
    v_mov_b32 v164, 0
    v_mov_b32 v165, 0
    v_mov_b32 v168, 0
    v_mov_b32 v169, 0
    v_mov_b32 v172, 0
    v_mov_b32 v173, 0
    v_mov_b32 v176, 0
    v_mov_b32 v177, 0
    v_mov_b32 v180, 0
    v_mov_b32 v181, 0
    v_mov_b32 v184, 0
    v_mov_b32 v185, 0
    v_mov_b32 v188, 0
    v_mov_b32 v189, 0
    v_mov_b32 v192, 0
    v_mov_b32 v193, 0
    v_mov_b32 v30, 0
    v_mov_b32 v31, 0
    v_and_b32 v18, 1, v1
    v_lshlrev_b32 v18, 4, v18
    v_mov_b32 v19, 0xffff
    v_lshlrev_b32 v19, v18, v19
    v_and_b32 v18, 2, v1
    v_cmp_eq_u32 vcc, 0, v18
    s_nop 1
    v_cndmask_b32 v13, 0, v19, vcc
    v_xor_b32 v14, v19, v13
    v_and_b32 v18, 3, v17
    v_lshlrev_b32 v18, 10, v18
    v_lshrrev_b32 v19, 2, v17
    v_lshl_add_u32 v18, v19, 8, v18
    v_xor_b32 v22, v16, v17
    v_lshl_add_u32 v18, v22, 4, v18
    v_add_u32 v8, s49, v18
    v_xor_b32 v9, 64, v8
    v_xor_b32 v10, 0x80, v8
    v_xor_b32 v11, 0xc0, v8
    v_lshlrev_b32 v18, 8, v19
    v_lshl_add_u32 v18, v16, 4, v18
    v_add_u32 v12, 152576, v18
    v_lshlrev_b32 v18, 6, v19
    v_add_u32 v243, 153600, v18
    s_lshl_b32 s50, s3, 3
    v_add_u32 v242, s50, v243
    v_mul_u32_u24 v18, 320, v16
    v_lshl_add_u32 v22, v17, 4, v18
    s_mul_i32 s50, s3, 2688
    s_add_u32 s50, s50, 131072
    v_add_u32 v244, s50, v22
    s_lshr_b32 s50, s3, 1
    s_lshr_b32 s55, s44, 2
    s_lshl_b32 s56, s55, 1
    s_xor_b32 s50, s50, s56
    s_mul_i32 s50, s50, 320
    s_and_b32 s56, s3, 1
    s_lshl_b32 s56, s56, 7
    s_add_u32 s50, s50, s56
    s_add_u32 s50, s50, 131072
    v_lshrrev_b32 v18, 3, v1
    v_lshlrev_b32 v18, 4, v18
    v_bfe_u32 v22, v1, 2, 1
    v_mul_u32_u24 v22, 1408, v22
    v_add_u32 v18, v18, v22
    v_and_b32 v22, 3, v1
    v_lshl_add_u32 v18, v22, 2, v18
    v_add_u32 v245, s50, v18
    v_lshlrev_b32 v252, 3, v0
    s_lshl_b32 s56, s55, 11
    v_xor_b32 v253, s56, v252
    v_lshlrev_b32 v18, 1, v0
    v_add_u32 v202, 152576, v18
    s_mul_i32 s56, s3, 144
    s_add_u32 s56, s56, 153856
    v_lshl_add_u32 v203, v1, 1, s56
    v_lshrrev_b32 v18, 1, v17
    v_xor_b32 v18, v18, v16
    v_lshlrev_b32 v18, 5, v18
    v_and_b32 v22, 1, v1
    v_lshl_add_u32 v18, v22, 4, v18
    v_lshl_add_u32 v246, v16, 10, v18
    s_and_b32 s56, s3, 1
    s_lshl_b32 s56, s56, 7
    v_xor_b32 v246, s56, v246
    v_lshlrev_b32 v18, 14, v16
    v_lshl_add_u32 v18, v19, 8, v18
    v_and_b32 v22, 1, v16
    v_lshl_add_u32 v22, v22, 2, v19
    v_xor_b32 v22, s3, v22
    v_lshl_add_u32 v18, v22, 5, v18
    v_and_b32 v22, 3, v17
    v_lshl_add_u32 v248, v22, 3, v18
    v_add_u32 v249, 0x10000, v248
    v_and_b32 v18, 7, v1
    v_lshlrev_b32 v254, 6, v18
    v_and_b32 v18, 3, v17
    v_mul_u32_u24 v18, 144, v18
    v_lshl_add_u32 v18, v16, 4, v18
    v_add_u32 v204, 153856, v18
    v_lshlrev_b32 v18, 11, v17
    v_lshl_add_u32 v15, v16, 9, v18
    v_lshlrev_b32 v22, 10, v16
    s_lshr_b32 s97, s27, 2
    s_lshl_b32 s97, s97, 3
    s_add_u32 s97, s97, s26
    s_lshl_b32 s97, s97, 2
    s_and_b32 s56, s27, 3
    s_add_u32 s97, s97, s56
    s_lshr_b32 s96, s97, 6
    s_lshl_b32 s96, s96, 17
    s_and_b32 s56, s97, 63
    s_lshl_b32 s56, s56, 5
    s_add_u32 s96, s96, s56
    s_lshl_b32 s97, s97, 2
    buffer_load_dword v7, v22, s[40:43], s97 offen
    s_waitcnt lgkmcnt(0)
    s_mul_i32 s46, s47, 0x9e3779b1
    s_add_u32 s46, s46, 0x7f4a7c15
    s_mov_b32 s100, s47
    s_mov_b32 s47, 100000
    v_mov_b32 v209, s46
    s_add_u32 s101, s101, s46
    s_lshl_b32 s50, s26, 7
    s_add_u32 s50, s50, 32768
    v_and_b32 v18, 31, v1
    v_lshl_add_u32 v250, v18, 2, s50
    s_cmp_lg_u32 s3, 7
    s_cbranch_scc1 L_noid
    s_lshl_b32 s51, s27, 2
    s_add_u32 s50, s50, s51
    v_mov_b32 v18, s101
    v_mov_b32 v22, s50
    s_mov_b64 exec, 1
    buffer_store_dword v18, v22, s[36:39], 0 offen
    s_mov_b64 exec, -1
L_noid:
    s_cmp_ge_u32 s3, 4
    s_cbranch_scc1 L_b1
    s_waitcnt vmcnt(13)
    v_lshlrev_b32 v64, 16, v24
    v_and_b32 v65, 0xffff0000, v24
    v_lshlrev_b32 v66, 16, v25
    v_and_b32 v67, 0xffff0000, v25
    v_lshlrev_b32 v68, 16, v26
    v_and_b32 v69, 0xffff0000, v26
    v_lshlrev_b32 v70, 16, v27
    v_and_b32 v71, 0xffff0000, v27
    v_add_f32 v72, v64, v65
    v_add_f32 v73, v66, v67
    v_add_f32 v74, v68, v69
    v_add_f32 v75, v70, v71
    v_add_f32 v72, v72, v73
    v_add_f32 v74, v74, v75
    v_add_f32 v72, v72, v74
    s_nop 1
    v_add_f32_dpp v72, v72, v72 row_ror:8 row_mask:0xf bank_mask:0xf
    s_nop 1
    v_add_f32_dpp v72, v72, v72 row_ror:4 row_mask:0xf bank_mask:0xf
    s_nop 1
    v_add_f32_dpp v72, v72, v72 row_ror:2 row_mask:0xf bank_mask:0xf
    s_nop 1
    v_add_f32_dpp v72, v72, v72 row_ror:1 row_mask:0xf bank_mask:0xf
    v_mov_b32 v73, v72
    s_nop 1
    v_permlane16_swap_b32 v72, v73
    v_add_f32 v72, v72, v73
    v_mov_b32 v73, v72
    s_nop 1
    v_permlane32_swap_b32 v72, v73
    v_add_f32 v72, v72, v73
    v_mul_f32 v72, 0x3b000000, v72
    v_sub_f32 v80, v64, v72
    v_sub_f32 v81, v65, v72
    v_sub_f32 v82, v66, v72
    v_sub_f32 v83, v67, v72
    v_sub_f32 v84, v68, v72
    v_sub_f32 v85, v69, v72
    v_sub_f32 v86, v70, v72
    v_sub_f32 v87, v71, v72
    v_mul_f32 v74, v80, v80
    v_fmac_f32 v74, v81, v81
    v_fmac_f32 v74, v82, v82
    v_fmac_f32 v74, v83, v83
    v_fmac_f32 v74, v84, v84
    v_fmac_f32 v74, v85, v85
    v_fmac_f32 v74, v86, v86
    v_fmac_f32 v74, v87, v87
    s_nop 1
    v_add_f32_dpp v74, v74, v74 row_ror:8 row_mask:0xf bank_mask:0xf
    s_nop 1
    v_add_f32_dpp v74, v74, v74 row_ror:4 row_mask:0xf bank_mask:0xf
    s_nop 1
    v_add_f32_dpp v74, v74, v74 row_ror:2 row_mask:0xf bank_mask:0xf
    s_nop 1
    v_add_f32_dpp v74, v74, v74 row_ror:1 row_mask:0xf bank_mask:0xf
    v_mov_b32 v73, v74
    s_nop 1
    v_permlane16_swap_b32 v74, v73
    v_add_f32 v74, v74, v73
    v_mov_b32 v73, v74
    s_nop 1
    v_permlane32_swap_b32 v74, v73
    v_add_f32 v74, v74, v73
    v_mul_f32 v74, 0x3b000000, v74
    v_cvt_pk_bf16_f32 v74, 0, v74
    v_add_f32 v74, 0x3727c5ac, v74
    v_cvt_pk_bf16_f32 v74, 0, v74
    v_sqrt_f32 v74, v74
    s_nop 0
    v_cvt_pk_bf16_f32 v74, 0, v74
    v_rcp_f32 v74, v74
    v_cvt_pk_bf16_f32 v72, 0, v72
    v_sub_f32 v80, v64, v72
    v_sub_f32 v81, v65, v72
    v_sub_f32 v82, v66, v72
    v_sub_f32 v83, v67, v72
    v_sub_f32 v84, v68, v72
    v_sub_f32 v85, v69, v72
    v_sub_f32 v86, v70, v72
    v_sub_f32 v87, v71, v72
    v_cvt_pk_bf16_f32 v80, 0, v80
    v_cvt_pk_bf16_f32 v81, 0, v81
    v_cvt_pk_bf16_f32 v82, 0, v82
    v_cvt_pk_bf16_f32 v83, 0, v83
    v_cvt_pk_bf16_f32 v84, 0, v84
    v_cvt_pk_bf16_f32 v85, 0, v85
    v_cvt_pk_bf16_f32 v86, 0, v86
    v_cvt_pk_bf16_f32 v87, 0, v87
    v_mul_f32 v80, v80, v74
    v_mul_f32 v81, v81, v74
    v_mul_f32 v82, v82, v74
    v_mul_f32 v83, v83, v74
    v_mul_f32 v84, v84, v74
    v_mul_f32 v85, v85, v74
    v_mul_f32 v86, v86, v74
    v_mul_f32 v87, v87, v74
    v_cvt_pk_bf16_f32 v88, v80, v81
    v_cvt_pk_bf16_f32 v89, v82, v83
    v_cvt_pk_bf16_f32 v90, v84, v85
    v_cvt_pk_bf16_f32 v91, v86, v87
    s_mul_i32 s50, s3, 528
    s_add_u32 s50, s50, 128000
    v_and_b32 v73, 31, v1
    v_lshlrev_b32 v73, 4, v73
    v_add_u32 v73, s50, v73
    s_bitcmp1_b32 s27, 3
    s_cselect_b32 s50, -1, 0
    s_mov_b32 exec_hi, s50
    s_not_b32 s50, s50
    s_mov_b32 exec_lo, s50
    ds_write_b128 v73, v[88:91]
    s_mov_b64 exec, -1
L_b1:
    s_waitcnt vmcnt(9) lgkmcnt(0)
    s_barrier
    s_cmp_ge_u32 s3, 4
    s_cbranch_scc1 L_gq
    s_cmp_eq_u32 s99, 0
    s_cbranch_scc1 L_gq
    v_mul_u32_u24 v18, 528, v19
    v_and_b32 v22, 3, v17
    v_lshl_add_u32 v18, v22, 6, v18
    v_lshl_add_u32 v18, v16, 4, v18
    v_add_u32 v22, 128000, v18
    ds_read_b128 v[32:35], v22
    ds_read_b128 v[36:39], v22 offset:256
    v_lshl_add_u32 v23, v16, 3, v19
    v_lshlrev_b32 v23, 7, v23
    v_and_b32 v24, 1, v16
    v_lshlrev_b32 v24, 1, v24
    v_bfe_u32 v25, v1, 3, 1
    v_add_u32 v24, v24, v25
    v_xor_b32 v24, s3, v24
    v_lshl_add_u32 v23, v24, 5, v23
    v_and_b32 v24, 3, v1
    v_lshl_add_u32 v23, v24, 3, v23
    v_add_u32 v23, 131072, v23
    ds_read_b64_tr_b16 v[210:211], v23 offset:0
    ds_read_b64_tr_b16 v[212:213], v23 offset:512
    ds_read_b64_tr_b16 v[214:215], v23 offset:4096
    ds_read_b64_tr_b16 v[216:217], v23 offset:4608
    ds_read_b64_tr_b16 v[218:219], v23 offset:8192
    ds_read_b64_tr_b16 v[220:221], v23 offset:8704
    ds_read_b64_tr_b16 v[222:223], v23 offset:12288
    ds_read_b64_tr_b16 v[224:225], v23 offset:12800
    ds_read_b64_tr_b16 v[226:227], v23 offset:16384
    ds_read_b64_tr_b16 v[228:229], v23 offset:16896
    ds_read_b64_tr_b16 v[230:231], v23 offset:20480
    ds_read_b64_tr_b16 v[232:233], v23 offset:20992
    ds_read_b64_tr_b16 v[234:235], v23 offset:24576
    ds_read_b64_tr_b16 v[236:237], v23 offset:25088
    ds_read_b64_tr_b16 v[238:239], v23 offset:28672
    ds_read_b64_tr_b16 v[240:241], v23 offset:29184
    v_mul_u32_u24 v18, s95, v16
    v_lshl_add_u32 v24, v17, 3, v18
    v_mov_b32 v21, s46
    v_mov_b32 v23, s46
    s_waitcnt lgkmcnt(14)
    v_mfma_f32_16x16x32_bf16 v[48:51], v[32:35], v[210:213], 0
    s_waitcnt lgkmcnt(12)
    v_mfma_f32_16x16x32_bf16 v[52:55], v[32:35], v[214:217], 0
    s_waitcnt lgkmcnt(10)
    v_mfma_f32_16x16x32_bf16 v[56:59], v[32:35], v[218:221], 0
    s_waitcnt lgkmcnt(8)
    v_mfma_f32_16x16x32_bf16 v[60:63], v[32:35], v[222:225], 0
    s_waitcnt lgkmcnt(6)
    v_mfma_f32_16x16x32_bf16 v[48:51], v[36:39], v[226:229], v[48:51]
    s_waitcnt lgkmcnt(4)
    v_mfma_f32_16x16x32_bf16 v[52:55], v[36:39], v[230:233], v[52:55]
    s_waitcnt lgkmcnt(2)
    v_mfma_f32_16x16x32_bf16 v[56:59], v[36:39], v[234:237], v[56:59]
    s_waitcnt lgkmcnt(0)
    v_mfma_f32_16x16x32_bf16 v[60:63], v[36:39], v[238:241], v[60:63]
    s_nop 3
    v_add_f32 v48, v48, v53
    s_nop 2
    v_add_f32 v58, v58, v63
    v_add_f32 v20, v48, v58
    s_nop 1
    v_mov_b32_dpp v22, v20 row_shl:1 row_mask:0xf bank_mask:0xf
    s_mov_b32 exec_lo, 0x55555555
    s_mov_b32 exec_hi, 0x55555555
    buffer_store_dwordx4 v[20:23], v24, s[36:39], s98 offen sc1
    s_mov_b64 exec, -1
L_gq:
    s_lshl_b32 s58, s45, 13
    s_add_u32 s58, s58, 65536
    s_add_u32 s59, s58, 4096
    s_waitcnt vmcnt(6)
    s_add_u32 m0, s49, 8192
    s_add_u32 s50, s48, 524288
    buffer_load_dwordx4 v2, s[4:7], s50 offen nt lds
    s_waitcnt vmcnt(6)
    s_add_u32 m0, s49, 9216
    s_xor_b32 s50, s48, 2048
    s_add_u32 s50, s50, 589824
    buffer_load_dwordx4 v3, s[4:7], s50 offen nt lds
    s_waitcnt vmcnt(6)
    s_add_u32 m0, s49, 10240
    s_add_u32 s50, s48, 655360
    buffer_load_dwordx4 v4, s[4:7], s50 offen nt lds
    s_waitcnt vmcnt(6)
    s_add_u32 m0, s49, 11264
    s_xor_b32 s50, s48, 2048
    s_add_u32 s50, s50, 720896
    buffer_load_dwordx4 v5, s[4:7], s50 offen nt lds
    s_waitcnt vmcnt(6)
    s_add_u32 m0, s49, 12288
    s_add_u32 s50, s48, 786432
    buffer_load_dwordx4 v2, s[4:7], s50 offen nt lds
    s_barrier
    s_waitcnt vmcnt(6)
    s_add_u32 m0, s49, 13312
    s_xor_b32 s50, s48, 2048
    s_add_u32 s50, s50, 851968
    buffer_load_dwordx4 v3, s[4:7], s50 offen nt lds
    s_waitcnt vmcnt(5)
    s_add_u32 m0, s49, 14336
    s_add_u32 s50, s48, 917504
    buffer_load_dwordx4 v4, s[4:7], s50 offen nt lds
    s_waitcnt vmcnt(5)
    s_add_u32 m0, s49, 15360
    s_xor_b32 s50, s48, 2048
    s_add_u32 s50, s50, 983040
    buffer_load_dwordx4 v5, s[4:7], s50 offen nt lds
    s_waitcnt vmcnt(5)
    s_add_u32 s50, s48, 0
    buffer_load_dwordx4 v[64:67], v6, s[8:11], s50 offen nt
    s_waitcnt vmcnt(5)
    s_xor_b32 s50, s48, 2048
    s_add_u32 s50, s50, 65536
    buffer_load_dwordx4 v[68:71], v6, s[8:11], s50 offen nt
    buffer_load_dwordx2 v[124:125], v252, s[36:39], s58 offen sc1
    buffer_load_dwordx2 v[126:127], v252, s[36:39], s59 offen sc1
    s_waitcnt vmcnt(7)
    s_add_u32 s50, s48, 131072
    buffer_load_dwordx4 v[72:75], v6, s[8:11], s50 offen nt
    s_waitcnt vmcnt(7)
    s_xor_b32 s50, s48, 2048
    s_add_u32 s50, s50, 196608
    buffer_load_dwordx4 v[76:79], v6, s[8:11], s50 offen nt
    s_waitcnt vmcnt(7)
    s_add_u32 s50, s48, 262144
    buffer_load_dwordx4 v[80:83], v6, s[8:11], s50 offen nt
    s_waitcnt vmcnt(7)
    s_xor_b32 s50, s48, 2048
    s_add_u32 s50, s50, 327680
    buffer_load_dwordx4 v[84:87], v6, s[8:11], s50 offen nt
    buffer_load_dwordx2 v[124:125], v252, s[36:39], s58 offen sc1
    buffer_load_dwordx2 v[126:127], v252, s[36:39], s59 offen sc1
    s_waitcnt vmcnt(9)
    s_add_u32 s50, s48, 393216
    buffer_load_dwordx4 v[88:91], v6, s[8:11], s50 offen nt
    s_waitcnt vmcnt(9)
    s_xor_b32 s50, s48, 2048
    s_add_u32 s50, s50, 458752
    buffer_load_dwordx4 v[92:95], v6, s[8:11], s50 offen nt
    s_waitcnt vmcnt(12)
    s_waitcnt vmcnt(8)
    v_bitop3_b32 v18, v125, v127, s46 bitop3:0x7e
    v_cmp_ne_u32 vcc, 0, v18
    s_cbranch_vccz L_q3
    s_waitcnt vmcnt(2)
L_chk_1:
    v_bitop3_b32 v18, v125, v127, s46 bitop3:0x7e
    v_cmp_ne_u32 vcc, 0, v18
    s_cbranch_vccz L_ok_2
    s_cmp_eq_u32 s47, 0
    s_cbranch_scc1 L_ok_2
    s_sub_u32 s47, s47, 1
    buffer_load_dwordx2 v[124:125], v252, s[36:39], s58 offen sc1
    buffer_load_dwordx2 v[126:127], v252, s[36:39], s59 offen sc1
    s_waitcnt vmcnt(0)
    s_branch L_chk_1
L_ok_2:
L_q3:
    v_add_f32 v18, v124, v126
    v_cvt_pk_bf16_f32 v18, v18, v18
    ds_write_b16 v202, v18
    s_waitcnt lgkmcnt(0)
    s_barrier
    buffer_load_dword v251, v250, s[36:39], 0 offen sc1
    s_lshl_b32 s53, s26, 19
    s_lshr_b32 s54, s27, 2
    s_lshl_b32 s54, s54, 16
    s_add_u32 s53, s53, s54
    s_lshl_b32 s54, s3, 13
    s_add_u32 s53, s53, s54
    s_and_b32 s54, s44, 3
    s_lshl_b32 s54, s54, 8
    s_add_u32 s53, s53, s54
    ds_read_b128 v[32:35], v12 offset:0
    ds_read_b128 v[36:39], v12 offset:64
    ds_read_b128 v[40:43], v12 offset:128
    ds_read_b128 v[44:47], v12 offset:192
    ds_read_b128 v[210:213], v8 offset:0
    ds_read_b128 v[214:217], v9 offset:0
    ds_read_b128 v[218:221], v10 offset:0
    ds_read_b128 v[222:225], v11 offset:0
    ds_read_b128 v[226:229], v8 offset:4096
    ds_read_b128 v[230:233], v9 offset:4096
    ds_read_b128 v[234:237], v10 offset:4096
    ds_read_b128 v[238:241], v11 offset:4096
    s_waitcnt lgkmcnt(4)
    v_mfma_f32_16x16x32_bf16 v[48:51], v[210:213], v[32:35], 0
    v_mfma_f32_16x16x32_bf16 v[48:51], v[214:217], v[36:39], v[48:51]
    v_mfma_f32_16x16x32_bf16 v[48:51], v[218:221], v[40:43], v[48:51]
    v_mfma_f32_16x16x32_bf16 v[48:51], v[222:225], v[44:47], v[48:51]
    ds_read_b128 v[210:213], v8 offset:8192
    ds_read_b128 v[214:217], v9 offset:8192
    ds_read_b128 v[218:221], v10 offset:8192
    ds_read_b128 v[222:225], v11 offset:8192
    s_waitcnt lgkmcnt(4)
    v_mfma_f32_16x16x32_bf16 v[52:55], v[226:229], v[32:35], 0
    v_mfma_f32_16x16x32_bf16 v[52:55], v[230:233], v[36:39], v[52:55]
    v_mfma_f32_16x16x32_bf16 v[52:55], v[234:237], v[40:43], v[52:55]
    v_mfma_f32_16x16x32_bf16 v[52:55], v[238:241], v[44:47], v[52:55]
    ds_read_b128 v[226:229], v8 offset:12288
    ds_read_b128 v[230:233], v9 offset:12288
    ds_read_b128 v[234:237], v10 offset:12288
    ds_read_b128 v[238:241], v11 offset:12288
    s_waitcnt lgkmcnt(4)
    v_mfma_f32_16x16x32_bf16 v[56:59], v[210:213], v[32:35], 0
    v_mfma_f32_16x16x32_bf16 v[56:59], v[214:217], v[36:39], v[56:59]
    v_mfma_f32_16x16x32_bf16 v[56:59], v[218:221], v[40:43], v[56:59]
    v_mfma_f32_16x16x32_bf16 v[56:59], v[222:225], v[44:47], v[56:59]
    s_waitcnt lgkmcnt(0)
    v_mfma_f32_16x16x32_bf16 v[60:63], v[226:229], v[32:35], 0
    v_mfma_f32_16x16x32_bf16 v[60:63], v[230:233], v[36:39], v[60:63]
    v_mfma_f32_16x16x32_bf16 v[60:63], v[234:237], v[40:43], v[60:63]
    v_mfma_f32_16x16x32_bf16 v[60:63], v[238:241], v[44:47], v[60:63]
    s_cmp_lg_u32 s3, 3
    s_cbranch_scc1 L_now2l
    v_and_b32 v18, 7, v1
    v_bfe_u32 v22, v1, 4, 1
    v_lshlrev_b32 v22, 1, v22
    v_xor_b32 v18, v18, v22
    v_lshlrev_b32 v18, 4, v18
    v_lshrrev_b32 v22, 3, v1
    v_lshl_add_u32 v20, v22, 10, v18
    v_xor_b32 v21, 64, v20
    s_cmp_lt_u32 s26, 4
    s_cselect_b32 s55, 3, 2
    s_lshr_b32 s56, s27, 3
    s_cmp_gt_u32 s56, s55
    s_cselect_b32 s30, 0, s30
    s_cselect_b32 s98, 0, 1
    s_min_u32 s56, s56, s55
    s_add_u32 s94, s94, s56
    s_lshl_b32 s51, s94, 16
    s_lshl_b32 s50, s44, 7
    s_add_u32 s51, s51, s50
    s_lshl_b32 s92, s94, 9
    s_add_u32 s92, s92, 326144
    s_mov_b32 s93, 0
    s_add_u32 m0, 57344, 0
    s_add_u32 s50, s51, 0
    buffer_load_dwordx4 v20, s[28:31], s50 offen nt lds
    s_add_u32 m0, 58368, 0
    s_add_u32 s50, s51, 8192
    buffer_load_dwordx4 v21, s[28:31], s50 offen nt lds
    s_add_u32 m0, 59392, 0
    s_add_u32 s50, s51, 16384
    buffer_load_dwordx4 v20, s[28:31], s50 offen nt lds
    s_add_u32 m0, 60416, 0
    s_add_u32 s50, s51, 24576
    buffer_load_dwordx4 v21, s[28:31], s50 offen nt lds
    s_add_u32 m0, 61440, 0
    s_add_u32 s50, s51, 32768
    buffer_load_dwordx4 v20, s[28:31], s50 offen nt lds
    s_add_u32 m0, 62464, 0
    s_add_u32 s50, s51, 40960
    buffer_load_dwordx4 v21, s[28:31], s50 offen nt lds
    s_add_u32 m0, 63488, 0
    s_add_u32 s50, s51, 49152
    buffer_load_dwordx4 v20, s[28:31], s50 offen nt lds
    s_add_u32 m0, 64512, 0
    s_add_u32 s50, s51, 57344
    buffer_load_dwordx4 v21, s[28:31], s50 offen nt lds
    s_add_u32 s50, s92, 0
    buffer_load_dwordx2 v[210:211], v252, s[36:39], s50 offen sc1
    s_add_u32 s50, s92, 14336
    buffer_load_dwordx2 v[212:213], v252, s[36:39], s50 offen sc1
    s_add_u32 s50, s92, 28672
    buffer_load_dwordx2 v[214:215], v252, s[36:39], s50 offen sc1
    s_add_u32 s50, s92, 43008
    buffer_load_dwordx2 v[216:217], v252, s[36:39], s50 offen sc1
    s_add_u32 s50, s92, 57344
    buffer_load_dwordx2 v[218:219], v252, s[36:39], s50 offen sc1
    s_add_u32 s50, s92, 71680
    buffer_load_dwordx2 v[220:221], v252, s[36:39], s50 offen sc1
    s_add_u32 s50, s92, 86016
    buffer_load_dwordx2 v[222:223], v252, s[36:39], s50 offen sc1
    s_add_u32 s50, s92, 100352
    buffer_load_dwordx2 v[224:225], v252, s[36:39], s50 offen sc1
    s_add_u32 s50, s92, 114688
    buffer_load_dwordx2 v[226:227], v252, s[36:39], s50 offen sc1
    s_add_u32 s50, s92, 129024
    buffer_load_dwordx2 v[228:229], v252, s[36:39], s50 offen sc1
    s_add_u32 s50, s92, 143360
    buffer_load_dwordx2 v[230:231], v252, s[36:39], s50 offen sc1
    s_add_u32 s50, s92, 157696
    buffer_load_dwordx2 v[232:233], v252, s[36:39], s50 offen sc1
    s_add_u32 s50, s92, 172032
    buffer_load_dwordx2 v[234:235], v252, s[36:39], s50 offen sc1
    s_add_u32 s50, s92, 186368
    buffer_load_dwordx2 v[236:237], v252, s[36:39], s50 offen sc1
    s_add_u32 s50, s92, 200704
    buffer_load_dwordx2 v[238:239], v252, s[36:39], s50 offen sc1
    s_add_u32 s50, s92, 215040
    buffer_load_dwordx2 v[240:241], v252, s[36:39], s50 offen sc1
L_now2l:
    s_add_u32 s50, s48, 524288
    buffer_load_dwordx4 v[96:99], v6, s[8:11], s50 offen nt
    s_xor_b32 s50, s48, 2048
    s_add_u32 s50, s50, 589824
    buffer_load_dwordx4 v[100:103], v6, s[8:11], s50 offen nt
    s_mov_b32 s51, 0x3db504f3
    v_cvt_pk_bf16_f32 v48, 0, v48
    v_cvt_pk_bf16_f32 v49, 0, v49
    v_cvt_pk_bf16_f32 v50, 0, v50
    v_cvt_pk_bf16_f32 v51, 0, v51
    v_cvt_pk_bf16_f32 v52, 0, v52
    v_cvt_pk_bf16_f32 v53, 0, v53
    v_cvt_pk_bf16_f32 v54, 0, v54
    v_cvt_pk_bf16_f32 v55, 0, v55
    v_cvt_pk_bf16_f32 v56, 0, v56
    v_cvt_pk_bf16_f32 v57, 0, v57
    v_cvt_pk_bf16_f32 v58, 0, v58
    v_cvt_pk_bf16_f32 v59, 0, v59
    v_cvt_pk_bf16_f32 v60, 0, v60
    v_cvt_pk_bf16_f32 v61, 0, v61
    v_cvt_pk_bf16_f32 v62, 0, v62
    v_cvt_pk_bf16_f32 v63, 0, v63
    v_mul_f32 v48, s51, v48
    v_mul_f32 v49, s51, v49
    v_mul_f32 v50, s51, v50
    v_mul_f32 v51, s51, v51
    v_mul_f32 v52, s51, v52
    v_mul_f32 v53, s51, v53
    v_mul_f32 v54, s51, v54
    v_mul_f32 v55, s51, v55
    v_mul_f32 v56, s51, v56
    v_mul_f32 v57, s51, v57
    v_mul_f32 v58, s51, v58
    v_mul_f32 v59, s51, v59
    v_mul_f32 v60, s51, v60
    v_mul_f32 v61, s51, v61
    v_mul_f32 v62, s51, v62
    v_mul_f32 v63, s51, v63
    v_cvt_pk_bf16_f32 v48, 0, v48
    v_cvt_pk_bf16_f32 v49, 0, v49
    v_cvt_pk_bf16_f32 v50, 0, v50
    v_cvt_pk_bf16_f32 v51, 0, v51
    v_cvt_pk_bf16_f32 v52, 0, v52
    v_cvt_pk_bf16_f32 v53, 0, v53
    v_cvt_pk_bf16_f32 v54, 0, v54
    v_cvt_pk_bf16_f32 v55, 0, v55
    v_cvt_pk_bf16_f32 v56, 0, v56
    v_cvt_pk_bf16_f32 v57, 0, v57
    v_cvt_pk_bf16_f32 v58, 0, v58
    v_cvt_pk_bf16_f32 v59, 0, v59
    v_cvt_pk_bf16_f32 v60, 0, v60
    v_cvt_pk_bf16_f32 v61, 0, v61
    v_cvt_pk_bf16_f32 v62, 0, v62
    v_cvt_pk_bf16_f32 v63, 0, v63
    v_max3_f32 v16, v48, v49, v50
    v_max3_f32 v16, v16, v51, v52
    v_max3_f32 v16, v16, v53, v54
    v_max3_f32 v16, v16, v55, v56
    v_max3_f32 v16, v16, v57, v58
    v_max3_f32 v16, v16, v59, v60
    v_max3_f32 v16, v16, v61, v62
    v_max_f32 v16, v16, v63
    v_mov_b32 v18, v16
    s_nop 1
    v_permlane16_swap_b32 v16, v18
    v_max_f32 v16, v16, v18
    v_mov_b32 v18, v16
    s_nop 1
    v_permlane32_swap_b32 v16, v18
    v_max_f32 v16, v16, v18
    s_mov_b32 s51, 0x3fb8aa3b
    v_mul_f32 v18, 0xbfb8aa3b, v16
    v_fma_f32 v48, v48, s51, v18
    v_fma_f32 v49, v49, s51, v18
    v_fma_f32 v50, v50, s51, v18
    v_fma_f32 v51, v51, s51, v18
    v_fma_f32 v52, v52, s51, v18
    v_fma_f32 v53, v53, s51, v18
    v_fma_f32 v54, v54, s51, v18
    v_fma_f32 v55, v55, s51, v18
    v_fma_f32 v56, v56, s51, v18
    v_fma_f32 v57, v57, s51, v18
    v_fma_f32 v58, v58, s51, v18
    v_fma_f32 v59, v59, s51, v18
    v_fma_f32 v60, v60, s51, v18
    v_fma_f32 v61, v61, s51, v18
    v_fma_f32 v62, v62, s51, v18
    v_fma_f32 v63, v63, s51, v18
    v_exp_f32 v48, v48
    v_exp_f32 v49, v49
    v_exp_f32 v50, v50
    v_exp_f32 v51, v51
    v_exp_f32 v52, v52
    v_exp_f32 v53, v53
    v_exp_f32 v54, v54
    v_exp_f32 v55, v55
    v_exp_f32 v56, v56
    v_exp_f32 v57, v57
    v_exp_f32 v58, v58
    v_exp_f32 v59, v59
    v_exp_f32 v60, v60
    v_exp_f32 v61, v61
    v_exp_f32 v62, v62
    v_exp_f32 v63, v63
    s_add_u32 s50, s48, 655360
    buffer_load_dwordx4 v[104:107], v6, s[8:11], s50 offen nt
    s_xor_b32 s50, s48, 2048
    s_add_u32 s50, s50, 720896
    buffer_load_dwordx4 v[108:111], v6, s[8:11], s50 offen nt
    v_add_f32 v17, v48, v49
    v_add_f32 v19, v50, v51
    v_add_f32 v17, v17, v52
    v_add_f32 v19, v19, v53
    v_add_f32 v17, v17, v54
    v_add_f32 v19, v19, v55
    v_add_f32 v17, v17, v56
    v_add_f32 v19, v19, v57
    v_add_f32 v17, v17, v58
    v_add_f32 v19, v19, v59
    v_add_f32 v17, v17, v60
    v_add_f32 v19, v19, v61
    v_add_f32 v17, v17, v62
    v_add_f32 v19, v19, v63
    v_add_f32 v17, v17, v19
    v_mov_b32 v18, v17
    s_nop 1
    v_permlane16_swap_b32 v17, v18
    v_add_f32 v17, v17, v18
    v_mov_b32 v18, v17
    s_nop 1
    v_permlane32_swap_b32 v17, v18
    v_add_f32 v17, v17, v18
    s_mov_b64 exec, 0x1111
    ds_write_b64 v242, v[16:17]
    s_mov_b64 exec, -1
    s_waitcnt lgkmcnt(0)
    s_barrier
    ds_read_b128 v[32:35], v243 offset:0
    ds_read_b128 v[36:39], v243 offset:16
    ds_read_b128 v[40:43], v243 offset:32
    ds_read_b128 v[44:47], v243 offset:48
    s_add_u32 s50, s48, 786432
    buffer_load_dwordx4 v[112:115], v6, s[8:11], s50 offen nt
    s_xor_b32 s50, s48, 2048
    s_add_u32 s50, s50, 851968
    buffer_load_dwordx4 v[116:119], v6, s[8:11], s50 offen nt
    s_waitcnt lgkmcnt(0)
    v_max3_f32 v18, v32, v34, v36
    v_max3_f32 v18, v18, v38, v40
    v_max3_f32 v18, v18, v42, v44
    v_max_f32 v18, v18, v46
    s_mov_b32 s51, 0x3fb8aa3b
    v_sub_f32 v19, v16, v18
    v_mul_f32 v19, s51, v19
    v_exp_f32 v19, v19
    s_cmp_eq_u32 s3, 3
    s_waitcnt vmcnt(30)
    s_cbranch_scc1 L_w_3
    s_waitcnt vmcnt(6)
L_w_3:
    v_cmp_ne_u32 vcc, s101, v251
    s_cmp_lg_u64 vcc, 0
    s_cselect_b32 s99, 1, 0
    s_cmp_lg_u32 s3, 2
    s_cbranch_scc1 L_nomlp
    v_sub_f32 v32, v32, v18
    v_sub_f32 v34, v34, v18
    v_sub_f32 v36, v36, v18
    v_sub_f32 v38, v38, v18
    v_sub_f32 v40, v40, v18
    v_sub_f32 v42, v42, v18
    v_sub_f32 v44, v44, v18
    v_sub_f32 v46, v46, v18
    v_mul_f32 v32, s51, v32
    v_mul_f32 v34, s51, v34
    v_mul_f32 v36, s51, v36
    v_mul_f32 v38, s51, v38
    v_mul_f32 v40, s51, v40
    v_mul_f32 v42, s51, v42
    v_mul_f32 v44, s51, v44
    v_mul_f32 v46, s51, v46
    v_exp_f32 v32, v32
    v_exp_f32 v34, v34
    v_exp_f32 v36, v36
    v_exp_f32 v38, v38
    v_exp_f32 v40, v40
    v_exp_f32 v42, v42
    v_exp_f32 v44, v44
    v_exp_f32 v46, v46
    v_mul_f32 v22, v32, v33
    v_fmac_f32 v22, v34, v35
    v_fmac_f32 v22, v36, v37
    v_fmac_f32 v22, v38, v39
    v_fmac_f32 v22, v40, v41
    v_fmac_f32 v22, v42, v43
    v_fmac_f32 v22, v44, v45
    v_fmac_f32 v22, v46, v47
    v_mov_b32 v20, v18
    v_mov_b32 v21, s46
    v_mov_b32 v23, s46
    v_lshlrev_b32 v24, 2, v1
    s_lshl_b32 s50, s45, 3
    s_add_u32 s50, s50, s44
    s_lshl_b32 s50, s50, 6
    s_add_u32 s50, s50, 589824
    s_mov_b64 exec, 0x1111
    s_cmp_lg_u32 s99, 0
    s_cbranch_scc1 L_far_4
    buffer_store_dwordx4 v[20:23], v24, s[36:39], s50 offen
    s_branch L_st_5
L_far_4:
    buffer_store_dwordx4 v[20:23], v24, s[36:39], s50 offen sc1
L_st_5:
    s_mov_b64 exec, -1
L_nomlp:
    v_mul_f32 v48, v48, v19
    v_mul_f32 v49, v49, v19
    v_mul_f32 v50, v50, v19
    v_mul_f32 v51, v51, v19
    v_mul_f32 v52, v52, v19
    v_mul_f32 v53, v53, v19
    v_mul_f32 v54, v54, v19
    v_mul_f32 v55, v55, v19
    v_mul_f32 v56, v56, v19
    v_mul_f32 v57, v57, v19
    v_mul_f32 v58, v58, v19
    v_mul_f32 v59, v59, v19
    v_mul_f32 v60, v60, v19
    v_mul_f32 v61, v61, v19
    v_mul_f32 v62, v62, v19
    v_mul_f32 v63, v63, v19
    v_cvt_pk_bf16_f32 v48, v48, v48
    v_cvt_pk_bf16_f32 v49, v49, v49
    v_cvt_pk_bf16_f32 v50, v50, v50
    v_cvt_pk_bf16_f32 v51, v51, v51
    v_cvt_pk_bf16_f32 v52, v52, v52
    v_cvt_pk_bf16_f32 v53, v53, v53
    v_cvt_pk_bf16_f32 v54, v54, v54
    v_cvt_pk_bf16_f32 v55, v55, v55
    v_cvt_pk_bf16_f32 v56, v56, v56
    v_cvt_pk_bf16_f32 v57, v57, v57
    v_cvt_pk_bf16_f32 v58, v58, v58
    v_cvt_pk_bf16_f32 v59, v59, v59
    v_cvt_pk_bf16_f32 v60, v60, v60
    v_cvt_pk_bf16_f32 v61, v61, v61
    v_cvt_pk_bf16_f32 v62, v62, v62
    v_cvt_pk_bf16_f32 v63, v63, v63
    v_and_b32 v130, v13, v48
    v_and_b32 v131, v14, v48
    v_and_b32 v134, v13, v49
    v_and_b32 v135, v14, v49
    v_and_b32 v138, v13, v50
    v_and_b32 v139, v14, v50
    v_and_b32 v142, v13, v51
    v_and_b32 v143, v14, v51
    v_and_b32 v146, v13, v52
    v_and_b32 v147, v14, v52
    v_and_b32 v150, v13, v53
    v_and_b32 v151, v14, v53
    v_and_b32 v154, v13, v54
    v_and_b32 v155, v14, v54
    v_and_b32 v158, v13, v55
    v_and_b32 v159, v14, v55
    v_and_b32 v162, v13, v56
    v_and_b32 v163, v14, v56
    v_and_b32 v166, v13, v57
    v_and_b32 v167, v14, v57
    v_and_b32 v170, v13, v58
    v_and_b32 v171, v14, v58
    v_and_b32 v174, v13, v59
    v_and_b32 v175, v14, v59
    v_and_b32 v178, v13, v60
    v_and_b32 v179, v14, v60
    v_and_b32 v182, v13, v61
    v_and_b32 v183, v14, v61
    v_and_b32 v186, v13, v62
    v_and_b32 v187, v14, v62
    v_and_b32 v190, v13, v63
    v_and_b32 v191, v14, v63
    s_add_u32 m0, s49, 0
    s_add_u32 s50, s53, 0
    buffer_load_dwordx4 v246, s[16:19], s50 offen nt lds
    s_add_u32 m0, s49, 1024
    s_add_u32 s50, s53, 4096
    buffer_load_dwordx4 v246, s[16:19], s50 offen nt lds
    s_add_u32 s50, s48, 917504
    buffer_load_dwordx4 v[120:123], v6, s[8:11], s50 offen nt
    s_xor_b32 s50, s48, 2048
    s_add_u32 s50, s50, 983040
    buffer_load_dwordx4 v[124:127], v6, s[8:11], s50 offen nt
    s_and_b32 s50, s3, 3
    s_lshl_b32 s50, s50, 3
    s_add_u32 s50, s50, s26
    s_lshr_b32 s51, s27, 3
    s_lshl_b32 s52, s50, 9
    s_lshl_b32 s54, s51, 4
    s_add_u32 s52, s52, s54
    s_add_u32 s52, s52, 589824
    s_lshl_b32 s50, s50, 15
    s_lshl_b32 s51, s51, 10
    s_add_u32 s51, s51, s50
    s_lshr_b32 s50, s44, 2
    s_lshl_b32 s50, s50, 9
    s_add_u32 s51, s51, s50
    s_and_b32 s50, s3, 3
    s_lshl_b32 s50, s50, 9
    s_sub_u32 s51, s51, s50
    s_add_u32 s51, s51, 1048576
    s_add_u32 s50, s44, 1
    s_and_b32 s50, s50, 7
    s_lshl_b32 s50, s50, 12
    s_add_u32 s20, s51, s50
    s_add_u32 s50, s44, 2
    s_and_b32 s50, s50, 7
    s_lshl_b32 s50, s50, 12
    s_add_u32 s21, s51, s50
    s_add_u32 s50, s44, 3
    s_and_b32 s50, s50, 7
    s_lshl_b32 s50, s50, 12
    s_add_u32 s22, s51, s50
    s_add_u32 s50, s44, 4
    s_and_b32 s50, s50, 7
    s_lshl_b32 s50, s50, 12
    s_add_u32 s23, s51, s50
    s_add_u32 s50, s44, 5
    s_and_b32 s50, s50, 7
    s_lshl_b32 s50, s50, 12
    s_add_u32 s24, s51, s50
    s_add_u32 s50, s44, 6
    s_and_b32 s50, s50, 7
    s_lshl_b32 s50, s50, 12
    s_add_u32 s25, s51, s50
    s_add_u32 s50, s44, 7
    s_and_b32 s50, s50, 7
    s_lshl_b32 s50, s50, 12
    s_add_u32 s28, s51, s50
    s_add_u32 s50, s44, 8
    s_and_b32 s50, s50, 7
    s_lshl_b32 s50, s50, 12
    s_add_u32 s29, s51, s50
    s_cmp_eq_u32 s3, 3
    s_waitcnt vmcnt(46)
    s_cbranch_scc1 L_w_6
    s_waitcnt vmcnt(22)
L_w_6:
    v_mfma_f32_16x16x32_bf16 v[194:197], v[130:133], v[64:67], 0
    v_mfma_f32_16x16x32_bf16 v[198:201], v[128:131], v[64:67], 0
    s_cmp_eq_u32 s3, 3
    s_waitcnt vmcnt(45)
    s_cbranch_scc1 L_w_7
    s_waitcnt vmcnt(21)
L_w_7:
    v_mfma_f32_16x16x32_bf16 v[194:197], v[134:137], v[68:71], v[194:197]
    v_mfma_f32_16x16x32_bf16 v[198:201], v[132:135], v[68:71], v[198:201]
    s_cmp_eq_u32 s3, 3
    s_waitcnt vmcnt(42)
    s_cbranch_scc1 L_w_8
    s_waitcnt vmcnt(18)
L_w_8:
    v_mfma_f32_16x16x32_bf16 v[194:197], v[138:141], v[72:75], v[194:197]
    v_mfma_f32_16x16x32_bf16 v[198:201], v[136:139], v[72:75], v[198:201]
    s_cmp_eq_u32 s3, 3
    s_waitcnt vmcnt(41)
    s_cbranch_scc1 L_w_9
    s_waitcnt vmcnt(17)
L_w_9:
    v_mfma_f32_16x16x32_bf16 v[194:197], v[142:145], v[76:79], v[194:197]
    v_mfma_f32_16x16x32_bf16 v[198:201], v[140:143], v[76:79], v[198:201]
    s_cmp_eq_u32 s3, 3
    s_waitcnt vmcnt(40)
    s_cbranch_scc1 L_w_10
    s_waitcnt vmcnt(16)
L_w_10:
    v_mfma_f32_16x16x32_bf16 v[194:197], v[146:149], v[80:83], v[194:197]
    v_mfma_f32_16x16x32_bf16 v[198:201], v[144:147], v[80:83], v[198:201]
    s_cmp_eq_u32 s3, 3
    s_waitcnt vmcnt(39)
    s_cbranch_scc1 L_w_11
    s_waitcnt vmcnt(15)
L_w_11:
    v_mfma_f32_16x16x32_bf16 v[194:197], v[150:153], v[84:87], v[194:197]
    v_mfma_f32_16x16x32_bf16 v[198:201], v[148:151], v[84:87], v[198:201]
    s_cmp_eq_u32 s3, 3
    s_waitcnt vmcnt(36)
    s_cbranch_scc1 L_w_12
    s_waitcnt vmcnt(12)
L_w_12:
    v_mfma_f32_16x16x32_bf16 v[194:197], v[154:157], v[88:91], v[194:197]
    v_mfma_f32_16x16x32_bf16 v[198:201], v[152:155], v[88:91], v[198:201]
    s_cmp_eq_u32 s3, 3
    s_waitcnt vmcnt(35)
    s_cbranch_scc1 L_w_13
    s_waitcnt vmcnt(11)
L_w_13:
    v_mfma_f32_16x16x32_bf16 v[194:197], v[158:161], v[92:95], v[194:197]
    v_mfma_f32_16x16x32_bf16 v[198:201], v[156:159], v[92:95], v[198:201]
    s_waitcnt vmcnt(9)
    v_mfma_f32_16x16x32_bf16 v[194:197], v[162:165], v[96:99], v[194:197]
    v_mfma_f32_16x16x32_bf16 v[198:201], v[160:163], v[96:99], v[198:201]
    s_waitcnt vmcnt(8)
    v_mfma_f32_16x16x32_bf16 v[194:197], v[166:169], v[100:103], v[194:197]
    v_mfma_f32_16x16x32_bf16 v[198:201], v[164:167], v[100:103], v[198:201]
    s_waitcnt vmcnt(7)
    s_cmp_lg_u32 s3, 3
    s_cbranch_scc1 L_now2
    v_bitop3_b32 v16, v211, v213, s46 bitop3:0x7e
    v_bitop3_b32 v17, v215, v217, s46 bitop3:0x7e
    v_bitop3_b32 v18, v219, v221, s46 bitop3:0x7e
    v_bitop3_b32 v19, v223, v225, s46 bitop3:0x7e
    v_bitop3_b32 v20, v227, v229, s46 bitop3:0x7e
    v_bitop3_b32 v21, v231, v233, s46 bitop3:0x7e
    v_bitop3_b32 v22, v235, v237, s46 bitop3:0x7e
    v_bitop3_b32 v23, v239, v241, s46 bitop3:0x7e
    v_or3_b32 v16, v16, v17, v18
    v_or3_b32 v19, v19, v20, v21
    v_or3_b32 v16, v16, v22, v23
    v_or_b32 v16, v16, v19
    v_cmp_ne_u32 vcc, 0, v16
    s_cbranch_vccz L_w2go_15
    s_mov_b32 s93, 1
    s_add_u32 s50, s92, 0
    buffer_load_dwordx2 v[210:211], v252, s[36:39], s50 offen sc1
    s_add_u32 s50, s92, 14336
    buffer_load_dwordx2 v[212:213], v252, s[36:39], s50 offen sc1
    s_add_u32 s50, s92, 28672
    buffer_load_dwordx2 v[214:215], v252, s[36:39], s50 offen sc1
    s_add_u32 s50, s92, 43008
    buffer_load_dwordx2 v[216:217], v252, s[36:39], s50 offen sc1
    s_add_u32 s50, s92, 57344
    buffer_load_dwordx2 v[218:219], v252, s[36:39], s50 offen sc1
    s_add_u32 s50, s92, 71680
    buffer_load_dwordx2 v[220:221], v252, s[36:39], s50 offen sc1
    s_add_u32 s50, s92, 86016
    buffer_load_dwordx2 v[222:223], v252, s[36:39], s50 offen sc1
    s_add_u32 s50, s92, 100352
    buffer_load_dwordx2 v[224:225], v252, s[36:39], s50 offen sc1
    s_add_u32 s50, s92, 114688
    buffer_load_dwordx2 v[226:227], v252, s[36:39], s50 offen sc1
    s_add_u32 s50, s92, 129024
    buffer_load_dwordx2 v[228:229], v252, s[36:39], s50 offen sc1
    s_add_u32 s50, s92, 143360
    buffer_load_dwordx2 v[230:231], v252, s[36:39], s50 offen sc1
    s_add_u32 s50, s92, 157696
    buffer_load_dwordx2 v[232:233], v252, s[36:39], s50 offen sc1
    s_add_u32 s50, s92, 172032
    buffer_load_dwordx2 v[234:235], v252, s[36:39], s50 offen sc1
    s_add_u32 s50, s92, 186368
    buffer_load_dwordx2 v[236:237], v252, s[36:39], s50 offen sc1
    s_add_u32 s50, s92, 200704
    buffer_load_dwordx2 v[238:239], v252, s[36:39], s50 offen sc1
    s_add_u32 s50, s92, 215040
    buffer_load_dwordx2 v[240:241], v252, s[36:39], s50 offen sc1
    s_branch L_w2skip_14
L_w2go_15:
    v_add_f32 v210, v210, v212
    v_add_f32 v214, v214, v216
    v_add_f32 v218, v218, v220
    v_add_f32 v222, v222, v224
    v_add_f32 v226, v226, v228
    v_add_f32 v230, v230, v232
    v_add_f32 v234, v234, v236
    v_add_f32 v238, v238, v240
    v_cvt_pk_bf16_f32 v210, 0, v210
    v_cvt_pk_bf16_f32 v214, 0, v214
    v_cvt_pk_bf16_f32 v218, 0, v218
    v_cvt_pk_bf16_f32 v222, 0, v222
    v_cvt_pk_bf16_f32 v226, 0, v226
    v_cvt_pk_bf16_f32 v230, 0, v230
    v_cvt_pk_bf16_f32 v234, 0, v234
    v_cvt_pk_bf16_f32 v238, 0, v238
    v_mul_f32 v16, 0xbfb8aa3b, v210
    v_mul_f32 v17, 0xbfb8aa3b, v214
    v_mul_f32 v18, 0xbfb8aa3b, v218
    v_mul_f32 v19, 0xbfb8aa3b, v222
    v_exp_f32 v16, v16
    v_exp_f32 v17, v17
    v_exp_f32 v18, v18
    v_exp_f32 v19, v19
    v_add_f32 v16, 1.0, v16
    v_add_f32 v17, 1.0, v17
    v_add_f32 v18, 1.0, v18
    v_add_f32 v19, 1.0, v19
    v_rcp_f32 v16, v16
    v_rcp_f32 v17, v17
    v_rcp_f32 v18, v18
    v_rcp_f32 v19, v19
    v_mul_f32 v16, v210, v16
    v_mul_f32 v17, v214, v17
    v_mul_f32 v18, v218, v18
    v_mul_f32 v19, v222, v19
    v_cvt_pk_bf16_f32 v16, 0, v16
    v_cvt_pk_bf16_f32 v17, 0, v17
    v_cvt_pk_bf16_f32 v18, 0, v18
    v_cvt_pk_bf16_f32 v19, 0, v19
    v_mul_f32 v16, v16, v226
    v_mul_f32 v17, v17, v230
    v_mul_f32 v18, v18, v234
    v_mul_f32 v19, v19, v238
    v_cvt_pk_bf16_f32 v16, v16, v16
    v_cvt_pk_bf16_f32 v17, v17, v17
    v_cvt_pk_bf16_f32 v18, v18, v18
    v_cvt_pk_bf16_f32 v19, v19, v19
    v_lshlrev_b32 v20, 1, v1
    v_add_u32 v20, 152576, v20
    v_and_b32 v21, 3, v1
    v_lshlrev_b32 v21, 7, v21
    v_lshrrev_b32 v22, 4, v1
    v_lshl_add_u32 v21, v22, 4, v21
    v_add_u32 v21, 152576, v21
    ds_write_b16 v20, v16 offset:0
    ds_write_b16 v20, v17 offset:128
    ds_write_b16 v20, v18 offset:256
    ds_write_b16 v20, v19 offset:384
    ds_read_b128 v[226:229], v21 offset:0
    ds_read_b128 v[230:233], v21 offset:64
    v_bfe_u32 v23, v1, 2, 2
    v_lshl_add_u32 v23, v22, 3, v23
    v_lshlrev_b32 v23, 7, v23
    v_and_b32 v20, 1, v22
    v_lshlrev_b32 v20, 1, v20
    v_bfe_u32 v21, v1, 3, 1
    v_add_u32 v20, v20, v21
    v_lshl_add_u32 v23, v20, 5, v23
    v_and_b32 v20, 3, v1
    v_lshl_add_u32 v23, v20, 3, v23
    v_add_u32 v28, 57344, v23
    v_xor_b32 v29, 32, v28
    v_xor_b32 v30, 64, v28
    v_xor_b32 v31, 0x60, v28
    ds_read_b64_tr_b16 v[64:65], v28 offset:0
    ds_read_b64_tr_b16 v[66:67], v28 offset:512
    ds_read_b64_tr_b16 v[68:69], v28 offset:4096
    ds_read_b64_tr_b16 v[70:71], v28 offset:4608
    ds_read_b64_tr_b16 v[72:73], v29 offset:0
    ds_read_b64_tr_b16 v[74:75], v29 offset:512
    ds_read_b64_tr_b16 v[76:77], v29 offset:4096
    ds_read_b64_tr_b16 v[78:79], v29 offset:4608
    ds_read_b64_tr_b16 v[80:81], v30 offset:0
    ds_read_b64_tr_b16 v[82:83], v30 offset:512
    ds_read_b64_tr_b16 v[84:85], v30 offset:4096
    ds_read_b64_tr_b16 v[86:87], v30 offset:4608
    ds_read_b64_tr_b16 v[88:89], v31 offset:0
    ds_read_b64_tr_b16 v[90:91], v31 offset:512
    ds_read_b64_tr_b16 v[92:93], v31 offset:4096
    ds_read_b64_tr_b16 v[94:95], v31 offset:4608
    v_cmp_eq_u32 s[56:57], 1, v22
    v_cmp_le_u32 s[58:59], 2, v22
    v_cmp_eq_u32 s[54:55], 3, v22
    v_and_b32 v20, 1, v1
    v_cmp_eq_u32 vcc, 1, v20
    v_lshlrev_b32 v20, 10, v20
    v_lshrrev_b32 v21, 1, v1
    v_lshl_add_u32 v20, v21, 4, v20
    s_lshl_b32 s50, s44, 5
    s_add_u32 s50, s50, s94
    s_lshl_b32 s50, s50, 11
    s_add_u32 s50, s50, 3145728
    s_cmp_eq_u32 s98, 0
    s_cselect_b32 s50, 0x2000000, s50
    s_waitcnt lgkmcnt(0)
    v_mfma_f32_16x16x32_bf16 v[48:51], v[226:229], v[64:67], 0
    v_mfma_f32_16x16x32_bf16 v[52:55], v[226:229], v[72:75], 0
    v_mfma_f32_16x16x32_bf16 v[56:59], v[226:229], v[80:83], 0
    v_mfma_f32_16x16x32_bf16 v[60:63], v[226:229], v[88:91], 0
    v_mfma_f32_16x16x32_bf16 v[48:51], v[230:233], v[68:71], v[48:51]
    v_mfma_f32_16x16x32_bf16 v[52:55], v[230:233], v[76:79], v[52:55]
    v_mfma_f32_16x16x32_bf16 v[56:59], v[230:233], v[84:87], v[56:59]
    v_mfma_f32_16x16x32_bf16 v[60:63], v[230:233], v[92:95], v[60:63]
    s_nop 5
    v_cndmask_b32 v48, v48, v52, s[56:57]
    s_nop 0
    v_cndmask_b32 v56, v56, v60, s[54:55]
    v_cndmask_b32 v49, v49, v53, s[56:57]
    v_cndmask_b32 v57, v57, v61, s[54:55]
    v_cndmask_b32 v50, v50, v54, s[56:57]
    v_cndmask_b32 v58, v58, v62, s[54:55]
    v_cndmask_b32 v51, v51, v55, s[56:57]
    v_cndmask_b32 v59, v59, v63, s[54:55]
    v_cndmask_b32 v48, v48, v56, s[58:59]
    v_cndmask_b32 v49, v49, v57, s[58:59]
    v_cndmask_b32 v50, v50, v58, s[58:59]
    v_cndmask_b32 v51, v51, v59, s[58:59]
    v_mov_b32_dpp v52, v48 quad_perm:[1,0,3,2] row_mask:0xf bank_mask:0xf
    v_mov_b32_dpp v53, v49 quad_perm:[1,0,3,2] row_mask:0xf bank_mask:0xf
    v_mov_b32_dpp v54, v50 quad_perm:[1,0,3,2] row_mask:0xf bank_mask:0xf
    v_mov_b32_dpp v55, v51 quad_perm:[1,0,3,2] row_mask:0xf bank_mask:0xf
    v_mov_b32 v65, s46
    v_mov_b32 v67, s46
    v_mov_b32 v69, s46
    v_mov_b32 v71, s46
    v_cndmask_b32 v64, v48, v54, vcc
    v_cndmask_b32 v66, v52, v50, vcc
    v_cndmask_b32 v68, v49, v55, vcc
    v_cndmask_b32 v70, v53, v51, vcc
    buffer_store_dwordx4 v[64:67], v20, s[36:39], s50 offen sc1
    buffer_store_dwordx4 v[68:71], v20, s[36:39], s50 offen offset:512 sc1
L_w2skip_14:
L_now2:
    v_mfma_f32_16x16x32_bf16 v[194:197], v[170:173], v[104:107], v[194:197]
    v_mfma_f32_16x16x32_bf16 v[198:201], v[168:171], v[104:107], v[198:201]
    s_cmp_eq_u32 s3, 3
    s_waitcnt vmcnt(8)
    s_cbranch_scc1 L_w_16
    s_waitcnt vmcnt(6)
L_w_16:
    v_mfma_f32_16x16x32_bf16 v[194:197], v[174:177], v[108:111], v[194:197]
    v_mfma_f32_16x16x32_bf16 v[198:201], v[172:175], v[108:111], v[198:201]
    s_cmp_eq_u32 s3, 3
    s_waitcnt vmcnt(7)
    s_cbranch_scc1 L_w_17
    s_waitcnt vmcnt(5)
L_w_17:
    v_mfma_f32_16x16x32_bf16 v[194:197], v[178:181], v[112:115], v[194:197]
    v_mfma_f32_16x16x32_bf16 v[198:201], v[176:179], v[112:115], v[198:201]
    s_cmp_eq_u32 s3, 3
    s_waitcnt vmcnt(6)
    s_cbranch_scc1 L_w_18
    s_waitcnt vmcnt(4)
L_w_18:
    v_mfma_f32_16x16x32_bf16 v[194:197], v[182:185], v[116:119], v[194:197]
    v_mfma_f32_16x16x32_bf16 v[198:201], v[180:183], v[116:119], v[198:201]
    s_cmp_eq_u32 s3, 3
    s_waitcnt vmcnt(3)
    s_cbranch_scc1 L_w_19
    s_waitcnt vmcnt(1)
L_w_19:
    v_mfma_f32_16x16x32_bf16 v[194:197], v[186:189], v[120:123], v[194:197]
    v_mfma_f32_16x16x32_bf16 v[198:201], v[184:187], v[120:123], v[198:201]
    s_cmp_eq_u32 s3, 3
    s_waitcnt vmcnt(2)
    s_cbranch_scc1 L_w_20
    s_waitcnt vmcnt(0)
L_w_20:
    buffer_load_dwordx4 v[24:27], v254, s[36:39], s52 offen sc1
    s_cmp_ge_u32 s3, 4
    s_cbranch_scc1 L_nog0
    buffer_load_dwordx2 v[32:33], v252, s[36:39], s20 offen sc1
    buffer_load_dwordx2 v[34:35], v252, s[36:39], s21 offen sc1
    buffer_load_dwordx2 v[36:37], v252, s[36:39], s22 offen sc1
    buffer_load_dwordx2 v[38:39], v252, s[36:39], s23 offen sc1
    buffer_load_dwordx2 v[40:41], v252, s[36:39], s24 offen sc1
    buffer_load_dwordx2 v[42:43], v252, s[36:39], s25 offen sc1
    buffer_load_dwordx2 v[44:45], v252, s[36:39], s28 offen sc1
    buffer_load_dwordx2 v[46:47], v252, s[36:39], s29 offen sc1
L_nog0:
    v_mfma_f32_16x16x32_bf16 v[194:197], v[190:193], v[124:127], v[194:197]
    v_mfma_f32_16x16x32_bf16 v[198:201], v[188:191], v[124:127], v[198:201]
    s_nop 6
    ds_write_b128 v244, v[194:197]
    ds_write_b128 v244, v[198:201] offset:1408
    s_cmp_lt_u32 s3, 4
    s_cbranch_scc1 L_nof2
    s_waitcnt vmcnt(1)
L_nof2:
    s_waitcnt lgkmcnt(0)
    s_barrier
    ds_read_b32 v48, v245 offset:0
    ds_read_b32 v49, v245 offset:2688
    ds_read_b32 v50, v245 offset:5376
    ds_read_b32 v51, v245 offset:8064
    ds_read_b32 v52, v245 offset:10752
    ds_read_b32 v53, v245 offset:13440
    ds_read_b32 v54, v245 offset:16128
    ds_read_b32 v55, v245 offset:18816
    s_lshl_b32 s50, s45, 3
    s_add_u32 s50, s50, s44
    s_lshl_b32 s57, s50, 12
    s_add_u32 s50, s57, 1048576
    s_waitcnt lgkmcnt(0)
    v_add_f32 v48, v48, v49
    v_add_f32 v50, v50, v51
    v_add_f32 v52, v52, v53
    v_add_f32 v54, v54, v55
    v_add_f32 v48, v48, v50
    v_add_f32 v52, v52, v54
    v_add_f32 v208, v48, v52
    s_cmp_lg_u32 s99, 0
    s_cbranch_scc1 L_far_21
    buffer_store_dwordx2 v[208:209], v253, s[36:39], s50 offen
    s_branch L_st_22
L_far_21:
    buffer_store_dwordx2 v[208:209], v253, s[36:39], s50 offen sc1
L_st_22:
    s_cmp_ge_u32 s3, 4
    s_cbranch_scc1 L_nof
    s_waitcnt vmcnt(9)
L_chk_23:
    v_bitop3_b32 v18, v25, v27, s46 bitop3:0x7e
    v_cmp_ne_u32 vcc, 0, v18
    s_cbranch_vccz L_ok_24
    s_cmp_eq_u32 s47, 0
    s_cbranch_scc1 L_ok_24
    s_sub_u32 s47, s47, 1
    buffer_load_dwordx4 v[24:27], v254, s[36:39], s52 offen sc1
    s_waitcnt vmcnt(0)
    s_branch L_chk_23
L_ok_24:
    v_mov_b32 v18, v24
    s_nop 1
    v_max_f32_dpp v18, v18, v18 quad_perm:[1,0,3,2] row_mask:0xf bank_mask:0xf
    s_nop 1
    v_max_f32_dpp v18, v18, v18 quad_perm:[2,3,0,1] row_mask:0xf bank_mask:0xf
    s_nop 1
    v_max_f32_dpp v18, v18, v18 row_half_mirror row_mask:0xf bank_mask:0xf
    s_mov_b32 s51, 0x3fb8aa3b
    v_sub_f32 v18, v24, v18
    v_mul_f32 v18, s51, v18
    v_exp_f32 v18, v18
    s_nop 0
    v_mul_f32 v19, v18, v26
    s_nop 1
    v_add_f32_dpp v19, v19, v19 quad_perm:[1,0,3,2] row_mask:0xf bank_mask:0xf
    s_nop 1
    v_add_f32_dpp v19, v19, v19 quad_perm:[2,3,0,1] row_mask:0xf bank_mask:0xf
    s_nop 1
    v_add_f32_dpp v19, v19, v19 row_half_mirror row_mask:0xf bank_mask:0xf
    v_rcp_f32 v19, v19
    s_nop 0
    v_mul_f32 v205, v18, v19
    s_add_u32 s50, s44, 1
    s_and_b32 s50, s50, 7
    v_readlane_b32 s4, v205, s50
    s_add_u32 s50, s44, 2
    s_and_b32 s50, s50, 7
    v_readlane_b32 s5, v205, s50
    s_add_u32 s50, s44, 3
    s_and_b32 s50, s50, 7
    v_readlane_b32 s6, v205, s50
    s_add_u32 s50, s44, 4
    s_and_b32 s50, s50, 7
    v_readlane_b32 s7, v205, s50
    s_add_u32 s50, s44, 5
    s_and_b32 s50, s50, 7
    v_readlane_b32 s12, v205, s50
    s_add_u32 s50, s44, 6
    s_and_b32 s50, s50, 7
    v_readlane_b32 s13, v205, s50
    s_add_u32 s50, s44, 7
    s_and_b32 s50, s50, 7
    v_readlane_b32 s14, v205, s50
    s_add_u32 s50, s44, 8
    s_and_b32 s50, s50, 7
    v_readlane_b32 s15, v205, s50
L_nof:
    s_cmp_lg_u32 s3, 3
    s_cbranch_scc1 L_now2b
    s_cmp_eq_u32 s93, 0
    s_cbranch_scc1 L_now2b
    s_waitcnt vmcnt(0)
L_chk_26:
    v_bitop3_b32 v16, v211, v213, s46 bitop3:0x7e
    v_bitop3_b32 v17, v215, v217, s46 bitop3:0x7e
    v_bitop3_b32 v18, v219, v221, s46 bitop3:0x7e
    v_bitop3_b32 v19, v223, v225, s46 bitop3:0x7e
    v_bitop3_b32 v20, v227, v229, s46 bitop3:0x7e
    v_bitop3_b32 v21, v231, v233, s46 bitop3:0x7e
    v_bitop3_b32 v22, v235, v237, s46 bitop3:0x7e
    v_bitop3_b32 v23, v239, v241, s46 bitop3:0x7e
    v_or3_b32 v16, v16, v17, v18
    v_or3_b32 v16, v16, v19, v20
    v_or3_b32 v16, v16, v21, v22
    v_or_b32 v16, v16, v23
    v_cmp_ne_u32 vcc, 0, v16
    s_cbranch_vccz L_ok_27
    s_cmp_eq_u32 s47, 0
    s_cbranch_scc1 L_ok_27
    s_sub_u32 s47, s47, 1
    s_add_u32 s50, s92, 0
    buffer_load_dwordx2 v[210:211], v252, s[36:39], s50 offen sc1
    s_add_u32 s50, s92, 14336
    buffer_load_dwordx2 v[212:213], v252, s[36:39], s50 offen sc1
    s_add_u32 s50, s92, 28672
    buffer_load_dwordx2 v[214:215], v252, s[36:39], s50 offen sc1
    s_add_u32 s50, s92, 43008
    buffer_load_dwordx2 v[216:217], v252, s[36:39], s50 offen sc1
    s_add_u32 s50, s92, 57344
    buffer_load_dwordx2 v[218:219], v252, s[36:39], s50 offen sc1
    s_add_u32 s50, s92, 71680
    buffer_load_dwordx2 v[220:221], v252, s[36:39], s50 offen sc1
    s_add_u32 s50, s92, 86016
    buffer_load_dwordx2 v[222:223], v252, s[36:39], s50 offen sc1
    s_add_u32 s50, s92, 100352
    buffer_load_dwordx2 v[224:225], v252, s[36:39], s50 offen sc1
    s_add_u32 s50, s92, 114688
    buffer_load_dwordx2 v[226:227], v252, s[36:39], s50 offen sc1
    s_add_u32 s50, s92, 129024
    buffer_load_dwordx2 v[228:229], v252, s[36:39], s50 offen sc1
    s_add_u32 s50, s92, 143360
    buffer_load_dwordx2 v[230:231], v252, s[36:39], s50 offen sc1
    s_add_u32 s50, s92, 157696
    buffer_load_dwordx2 v[232:233], v252, s[36:39], s50 offen sc1
    s_add_u32 s50, s92, 172032
    buffer_load_dwordx2 v[234:235], v252, s[36:39], s50 offen sc1
    s_add_u32 s50, s92, 186368
    buffer_load_dwordx2 v[236:237], v252, s[36:39], s50 offen sc1
    s_add_u32 s50, s92, 200704
    buffer_load_dwordx2 v[238:239], v252, s[36:39], s50 offen sc1
    s_add_u32 s50, s92, 215040
    buffer_load_dwordx2 v[240:241], v252, s[36:39], s50 offen sc1
    s_waitcnt vmcnt(0)
    s_branch L_chk_26
L_ok_27:
    v_add_f32 v210, v210, v212
    v_add_f32 v214, v214, v216
    v_add_f32 v218, v218, v220
    v_add_f32 v222, v222, v224
    v_add_f32 v226, v226, v228
    v_add_f32 v230, v230, v232
    v_add_f32 v234, v234, v236
    v_add_f32 v238, v238, v240
    v_cvt_pk_bf16_f32 v210, 0, v210
    v_cvt_pk_bf16_f32 v214, 0, v214
    v_cvt_pk_bf16_f32 v218, 0, v218
    v_cvt_pk_bf16_f32 v222, 0, v222
    v_cvt_pk_bf16_f32 v226, 0, v226
    v_cvt_pk_bf16_f32 v230, 0, v230
    v_cvt_pk_bf16_f32 v234, 0, v234
    v_cvt_pk_bf16_f32 v238, 0, v238
    v_mul_f32 v16, 0xbfb8aa3b, v210
    v_mul_f32 v17, 0xbfb8aa3b, v214
    v_mul_f32 v18, 0xbfb8aa3b, v218
    v_mul_f32 v19, 0xbfb8aa3b, v222
    v_exp_f32 v16, v16
    v_exp_f32 v17, v17
    v_exp_f32 v18, v18
    v_exp_f32 v19, v19
    v_add_f32 v16, 1.0, v16
    v_add_f32 v17, 1.0, v17
    v_add_f32 v18, 1.0, v18
    v_add_f32 v19, 1.0, v19
    v_rcp_f32 v16, v16
    v_rcp_f32 v17, v17
    v_rcp_f32 v18, v18
    v_rcp_f32 v19, v19
    v_mul_f32 v16, v210, v16
    v_mul_f32 v17, v214, v17
    v_mul_f32 v18, v218, v18
    v_mul_f32 v19, v222, v19
    v_cvt_pk_bf16_f32 v16, 0, v16
    v_cvt_pk_bf16_f32 v17, 0, v17
    v_cvt_pk_bf16_f32 v18, 0, v18
    v_cvt_pk_bf16_f32 v19, 0, v19
    v_mul_f32 v16, v16, v226
    v_mul_f32 v17, v17, v230
    v_mul_f32 v18, v18, v234
    v_mul_f32 v19, v19, v238
    v_cvt_pk_bf16_f32 v16, v16, v16
    v_cvt_pk_bf16_f32 v17, v17, v17
    v_cvt_pk_bf16_f32 v18, v18, v18
    v_cvt_pk_bf16_f32 v19, v19, v19
    v_lshlrev_b32 v20, 1, v1
    v_add_u32 v20, 152576, v20
    v_and_b32 v21, 3, v1
    v_lshlrev_b32 v21, 7, v21
    v_lshrrev_b32 v22, 4, v1
    v_lshl_add_u32 v21, v22, 4, v21
    v_add_u32 v21, 152576, v21
    ds_write_b16 v20, v16 offset:0
    ds_write_b16 v20, v17 offset:128
    ds_write_b16 v20, v18 offset:256
    ds_write_b16 v20, v19 offset:384
    ds_read_b128 v[226:229], v21 offset:0
    ds_read_b128 v[230:233], v21 offset:64
    v_bfe_u32 v23, v1, 2, 2
    v_lshl_add_u32 v23, v22, 3, v23
    v_lshlrev_b32 v23, 7, v23
    v_and_b32 v20, 1, v22
    v_lshlrev_b32 v20, 1, v20
    v_bfe_u32 v21, v1, 3, 1
    v_add_u32 v20, v20, v21
    v_lshl_add_u32 v23, v20, 5, v23
    v_and_b32 v20, 3, v1
    v_lshl_add_u32 v23, v20, 3, v23
    v_add_u32 v28, 57344, v23
    v_xor_b32 v29, 32, v28
    v_xor_b32 v30, 64, v28
    v_xor_b32 v31, 0x60, v28
    ds_read_b64_tr_b16 v[64:65], v28 offset:0
    ds_read_b64_tr_b16 v[66:67], v28 offset:512
    ds_read_b64_tr_b16 v[68:69], v28 offset:4096
    ds_read_b64_tr_b16 v[70:71], v28 offset:4608
    ds_read_b64_tr_b16 v[72:73], v29 offset:0
    ds_read_b64_tr_b16 v[74:75], v29 offset:512
    ds_read_b64_tr_b16 v[76:77], v29 offset:4096
    ds_read_b64_tr_b16 v[78:79], v29 offset:4608
    ds_read_b64_tr_b16 v[80:81], v30 offset:0
    ds_read_b64_tr_b16 v[82:83], v30 offset:512
    ds_read_b64_tr_b16 v[84:85], v30 offset:4096
    ds_read_b64_tr_b16 v[86:87], v30 offset:4608
    ds_read_b64_tr_b16 v[88:89], v31 offset:0
    ds_read_b64_tr_b16 v[90:91], v31 offset:512
    ds_read_b64_tr_b16 v[92:93], v31 offset:4096
    ds_read_b64_tr_b16 v[94:95], v31 offset:4608
    v_cmp_eq_u32 s[56:57], 1, v22
    v_cmp_le_u32 s[58:59], 2, v22
    v_cmp_eq_u32 s[54:55], 3, v22
    v_and_b32 v20, 1, v1
    v_cmp_eq_u32 vcc, 1, v20
    v_lshlrev_b32 v20, 10, v20
    v_lshrrev_b32 v21, 1, v1
    v_lshl_add_u32 v20, v21, 4, v20
    s_lshl_b32 s50, s44, 5
    s_add_u32 s50, s50, s94
    s_lshl_b32 s50, s50, 11
    s_add_u32 s50, s50, 3145728
    s_cmp_eq_u32 s98, 0
    s_cselect_b32 s50, 0x2000000, s50
    s_waitcnt lgkmcnt(0)
    v_mfma_f32_16x16x32_bf16 v[48:51], v[226:229], v[64:67], 0
    v_mfma_f32_16x16x32_bf16 v[52:55], v[226:229], v[72:75], 0
    v_mfma_f32_16x16x32_bf16 v[56:59], v[226:229], v[80:83], 0
    v_mfma_f32_16x16x32_bf16 v[60:63], v[226:229], v[88:91], 0
    v_mfma_f32_16x16x32_bf16 v[48:51], v[230:233], v[68:71], v[48:51]
    v_mfma_f32_16x16x32_bf16 v[52:55], v[230:233], v[76:79], v[52:55]
    v_mfma_f32_16x16x32_bf16 v[56:59], v[230:233], v[84:87], v[56:59]
    v_mfma_f32_16x16x32_bf16 v[60:63], v[230:233], v[92:95], v[60:63]
    s_nop 5
    v_cndmask_b32 v48, v48, v52, s[56:57]
    s_nop 0
    v_cndmask_b32 v56, v56, v60, s[54:55]
    v_cndmask_b32 v49, v49, v53, s[56:57]
    v_cndmask_b32 v57, v57, v61, s[54:55]
    v_cndmask_b32 v50, v50, v54, s[56:57]
    v_cndmask_b32 v58, v58, v62, s[54:55]
    v_cndmask_b32 v51, v51, v55, s[56:57]
    v_cndmask_b32 v59, v59, v63, s[54:55]
    v_cndmask_b32 v48, v48, v56, s[58:59]
    v_cndmask_b32 v49, v49, v57, s[58:59]
    v_cndmask_b32 v50, v50, v58, s[58:59]
    v_cndmask_b32 v51, v51, v59, s[58:59]
    v_mov_b32_dpp v52, v48 quad_perm:[1,0,3,2] row_mask:0xf bank_mask:0xf
    v_mov_b32_dpp v53, v49 quad_perm:[1,0,3,2] row_mask:0xf bank_mask:0xf
    v_mov_b32_dpp v54, v50 quad_perm:[1,0,3,2] row_mask:0xf bank_mask:0xf
    v_mov_b32_dpp v55, v51 quad_perm:[1,0,3,2] row_mask:0xf bank_mask:0xf
    v_mov_b32 v65, s46
    v_mov_b32 v67, s46
    v_mov_b32 v69, s46
    v_mov_b32 v71, s46
    v_cndmask_b32 v64, v48, v54, vcc
    v_cndmask_b32 v66, v52, v50, vcc
    v_cndmask_b32 v68, v49, v55, vcc
    v_cndmask_b32 v70, v53, v51, vcc
    buffer_store_dwordx4 v[64:67], v20, s[36:39], s50 offen sc1
    buffer_store_dwordx4 v[68:71], v20, s[36:39], s50 offen offset:512 sc1
L_w2skip_25:
L_now2b:
    ds_read_b64_tr_b16 v[210:211], v248
    ds_read_b64_tr_b16 v[212:213], v248 offset:1024
    ds_read_b64_tr_b16 v[214:215], v249
    ds_read_b64_tr_b16 v[216:217], v249 offset:1024
    s_cmp_ge_u32 s3, 4
    s_cbranch_scc1 L_nogather
    s_waitcnt vmcnt(1)
L_gchk_28:
    v_bitop3_b32 v16, v33, v35, s46 bitop3:0x7e
    v_bitop3_b32 v17, v37, v39, s46 bitop3:0x7e
    v_bitop3_b32 v18, v41, v43, s46 bitop3:0x7e
    v_bitop3_b32 v19, v45, v47, s46 bitop3:0x7e
    v_or3_b32 v16, v16, v17, v18
    v_or_b32 v16, v16, v19
    v_cmp_ne_u32 vcc, 0, v16
    s_cbranch_vccz L_gok_29
    s_cmp_eq_u32 s47, 0
    s_cbranch_scc1 L_gok_29
    s_sub_u32 s47, s47, 1
    v_cmp_ne_u32 vcc, s46, v33
    s_cbranch_vccz L_gs_30
    buffer_load_dwordx2 v[32:33], v252, s[36:39], s20 offen sc1
L_gs_30:
    v_cmp_ne_u32 vcc, s46, v35
    s_cbranch_vccz L_gs_31
    buffer_load_dwordx2 v[34:35], v252, s[36:39], s21 offen sc1
L_gs_31:
    v_cmp_ne_u32 vcc, s46, v37
    s_cbranch_vccz L_gs_32
    buffer_load_dwordx2 v[36:37], v252, s[36:39], s22 offen sc1
L_gs_32:
    v_cmp_ne_u32 vcc, s46, v39
    s_cbranch_vccz L_gs_33
    buffer_load_dwordx2 v[38:39], v252, s[36:39], s23 offen sc1
L_gs_33:
    v_cmp_ne_u32 vcc, s46, v41
    s_cbranch_vccz L_gs_34
    buffer_load_dwordx2 v[40:41], v252, s[36:39], s24 offen sc1
L_gs_34:
    v_cmp_ne_u32 vcc, s46, v43
    s_cbranch_vccz L_gs_35
    buffer_load_dwordx2 v[42:43], v252, s[36:39], s25 offen sc1
L_gs_35:
    v_cmp_ne_u32 vcc, s46, v45
    s_cbranch_vccz L_gs_36
    buffer_load_dwordx2 v[44:45], v252, s[36:39], s28 offen sc1
L_gs_36:
    v_cmp_ne_u32 vcc, s46, v47
    s_cbranch_vccz L_gs_37
    buffer_load_dwordx2 v[46:47], v252, s[36:39], s29 offen sc1
L_gs_37:
    s_waitcnt vmcnt(0)
    s_branch L_gchk_28
L_gok_29:
    v_mul_f32 v18, s4, v32
    v_mul_f32 v19, s5, v34
    v_fmac_f32 v18, s6, v36
    v_fmac_f32 v19, s7, v38
    v_fmac_f32 v18, s12, v40
    v_fmac_f32 v19, s13, v42
    v_fmac_f32 v18, s14, v44
    v_fmac_f32 v19, s15, v46
    v_add_f32 v18, v18, v19
    v_cvt_pk_bf16_f32 v18, v18, v18
    ds_write_b16 v203, v18
    s_branch L_ojoin
L_nogather:
    s_cmp_lg_u32 s3, 4
    s_cbranch_scc1 L_ojoin
    s_lshr_b32 s50, s97, 7
    s_lshl_b32 s55, s50, 16
    s_and_b32 s50, s97, 124
    s_lshl_b32 s50, s50, 2
    s_add_u32 s55, s55, s50
    s_add_u32 s55, s55, 3145728
    v_mov_b32 v36, 0
    v_mov_b32 v37, s46
    v_mov_b32 v38, 0
    v_mov_b32 v39, s46
L_ojoin:
    s_waitcnt lgkmcnt(0)
    s_barrier
    ds_read_b128 v[64:67], v204
    ds_read_b128 v[68:71], v204 offset:64
    s_and_b32 s50, s44, 3
    s_lshl_b32 s50, s50, 6
    s_lshl_b32 s51, s26, 3
    s_add_u32 s50, s50, s51
    s_lshr_b32 s54, s27, 2
    s_add_u32 s50, s50, s54
    s_lshl_b32 s50, s50, 11
    s_lshl_b32 s51, s3, 8
    s_add_u32 s50, s50, s51
    s_add_u32 s50, s50, 2097152
    v_mov_b32 v24, 0x07060500
    v_mov_b32 v25, 0x07060501
    v_mov_b32 v26, 0x07060502
    v_mov_b32 v27, 0x07060503
    s_waitcnt lgkmcnt(1)
    v_mfma_f32_16x16x32_bf16 v[48:51], v[64:67], v[210:213], 0
    s_waitcnt lgkmcnt(0)
    v_mfma_f32_16x16x32_bf16 v[48:51], v[68:71], v[214:217], v[48:51]
    s_nop 7
    v_perm_b32 v20, v48, v209, v24
    v_perm_b32 v21, v49, v209, v25
    v_perm_b32 v22, v50, v209, v26
    v_perm_b32 v23, v51, v209, v27
    s_mov_b64 exec, 0xffff
    buffer_store_dwordx4 v[20:23], v6, s[36:39], s50 offen sc1
    s_mov_b64 exec, -1
    s_cmp_lg_u32 s3, 4
    s_cbranch_scc1 L_fin
    s_add_u32 s59, s96, 2097152
    v_lshlrev_b32 v27, 11, v1
    buffer_load_dwordx4 v[32:35], v15, s[36:39], s55 offen sc1
    s_add_u32 s50, s55, 32768
    s_mov_b32 exec_lo, 0x0fff0fff
    s_mov_b32 exec_hi, 0x0fff0fff
    buffer_load_dwordx4 v[36:39], v15, s[36:39], s50 offen sc1
    s_mov_b64 exec, -1
    s_waitcnt vmcnt(0)
L_chk_38:
    v_bitop3_b32 v48, v33, v35, s46 bitop3:0x7e
    v_bitop3_b32 v49, v37, v39, s46 bitop3:0x7e
    v_or_b32 v48, v48, v49
    v_cmp_ne_u32 vcc, 0, v48
    s_cbranch_vccz L_ok_39
    s_cmp_eq_u32 s47, 0
    s_cbranch_scc1 L_ok_39
    s_sub_u32 s47, s47, 1
    buffer_load_dwordx4 v[32:35], v15, s[36:39], s55 offen sc1
    s_add_u32 s50, s55, 32768
    s_mov_b32 exec_lo, 0x0fff0fff
    s_mov_b32 exec_hi, 0x0fff0fff
    buffer_load_dwordx4 v[36:39], v15, s[36:39], s50 offen sc1
    s_mov_b64 exec, -1
    s_waitcnt vmcnt(0)
    s_branch L_chk_38
L_ok_39:
    buffer_load_dwordx4 v[64:67], v27, s[36:39], s59 offen sc1
    buffer_load_dwordx4 v[68:71], v27, s[36:39], s59 offen offset:16 sc1
    v_add_f32 v20, v32, v36
    v_add_f32 v21, v34, v38
    s_nop 0
    v_add_f32_dpp v20, v20, v20 row_ror:8 row_mask:0xf bank_mask:0xf
    v_add_f32_dpp v21, v21, v21 row_ror:8 row_mask:0xf bank_mask:0xf
    s_nop 0
    v_add_f32_dpp v20, v20, v20 row_ror:4 row_mask:0xf bank_mask:0xf
    v_add_f32_dpp v21, v21, v21 row_ror:4 row_mask:0xf bank_mask:0xf
    s_nop 0
    v_add_f32_dpp v20, v20, v20 row_ror:2 row_mask:0xf bank_mask:0xf
    v_add_f32_dpp v21, v21, v21 row_ror:2 row_mask:0xf bank_mask:0xf
    s_nop 0
    v_add_f32_dpp v20, v20, v20 row_ror:1 row_mask:0xf bank_mask:0xf
    v_add_f32_dpp v21, v21, v21 row_ror:1 row_mask:0xf bank_mask:0xf
    v_cvt_pk_bf16_f32 v20, 0, v20
    v_cvt_pk_bf16_f32 v21, 0, v21
    v_mul_f32 v18, 0xbfb8aa3b, v20
    v_exp_f32 v18, v18
    s_nop 0
    v_add_f32 v18, 1.0, v18
    v_rcp_f32 v18, v18
    s_nop 0
    v_mul_f32 v18, v20, v18
    v_cvt_pk_bf16_f32 v22, 0, v18
    v_mul_f32 v19, 0xbfb8aa3b, v21
    v_exp_f32 v19, v19
    s_nop 0
    v_add_f32 v19, 1.0, v19
    v_rcp_f32 v19, v19
    s_nop 0
    v_mul_f32 v19, v21, v19
    v_cvt_pk_bf16_f32 v23, 0, v19
    v_lshlrev_b32 v24, 16, v7
    v_and_b32 v25, 0xffff0000, v7
    v_lshrrev_b32 v26, 4, v1
    v_lshlrev_b32 v26, 10, v26
    s_mov_b32 s54, 0x0c0c0400
    s_mov_b32 s55, 0x04000c0c
    s_waitcnt vmcnt(0)
L_schk_40:
    v_perm_b32 v28, v65, v64, s54
    v_perm_b32 v29, v67, v66, s55
    v_perm_b32 v30, v69, v68, s54
    v_perm_b32 v31, v71, v70, s55
    v_or_b32 v28, v28, v29
    v_or_b32 v30, v30, v31
    v_bitop3_b32 v28, v28, v30, s46 bitop3:0x7e
    v_cmp_ne_u32 vcc, 0, v28
    s_cbranch_vccz L_sok_41
    s_cmp_eq_u32 s47, 0
    s_cbranch_scc1 L_sok_41
    s_sub_u32 s47, s47, 1
    s_mov_b64 exec, vcc
    buffer_load_dwordx4 v[64:67], v27, s[36:39], s59 offen sc1
    buffer_load_dwordx4 v[68:71], v27, s[36:39], s59 offen offset:16 sc1
    s_mov_b64 exec, -1
    s_waitcnt vmcnt(0)
    s_branch L_schk_40
L_sok_41:
    v_and_b32 v64, 0xffffff00, v64
    v_and_b32 v65, 0xffffff00, v65
    v_and_b32 v66, 0xffffff00, v66
    v_and_b32 v67, 0xffffff00, v67
    v_and_b32 v68, 0xffffff00, v68
    v_and_b32 v69, 0xffffff00, v69
    v_and_b32 v70, 0xffffff00, v70
    v_and_b32 v71, 0xffffff00, v71
    v_permlane32_swap_b32 v64, v66
    v_permlane32_swap_b32 v65, v67
    v_permlane32_swap_b32 v68, v70
    v_permlane32_swap_b32 v69, v71
    v_add_f32 v64, v64, v66
    v_add_f32 v65, v65, v67
    v_add_f32 v68, v68, v70
    v_add_f32 v69, v69, v71
    v_permlane16_swap_b32 v64, v65
    s_nop 0
    v_permlane16_swap_b32 v68, v69
    v_add_f32 v20, v64, v65
    v_add_f32 v21, v68, v69
    s_nop 0
    v_add_f32_dpp v20, v20, v20 row_ror:8 row_mask:0xf bank_mask:0xf
    v_add_f32_dpp v21, v21, v21 row_ror:8 row_mask:0xf bank_mask:0xf
    s_nop 0
    v_add_f32_dpp v20, v20, v20 row_ror:4 row_mask:0xf bank_mask:0xf
    v_add_f32_dpp v21, v21, v21 row_ror:4 row_mask:0xf bank_mask:0xf
    s_nop 0
    v_add_f32_dpp v20, v20, v20 row_ror:2 row_mask:0xf bank_mask:0xf
    v_add_f32_dpp v21, v21, v21 row_ror:2 row_mask:0xf bank_mask:0xf
    s_nop 0
    v_add_f32_dpp v20, v20, v20 row_ror:1 row_mask:0xf bank_mask:0xf
    v_add_f32_dpp v21, v21, v21 row_ror:1 row_mask:0xf bank_mask:0xf
    v_cvt_pk_bf16_f32 v20, 0, v20
    v_cvt_pk_bf16_f32 v21, 0, v21
    v_mul_f32 v20, v20, v22
    v_mul_f32 v21, v21, v23
    v_cvt_pk_bf16_f32 v20, 0, v20
    v_cvt_pk_bf16_f32 v21, 0, v21
    v_add_f32 v20, v24, v20
    v_add_f32 v21, v25, v21
    v_cvt_pk_bf16_f32 v20, v20, v21
    s_mov_b32 exec_lo, 0x00010001
    s_mov_b32 exec_hi, 0x00010001
    buffer_store_dword v20, v26, s[32:35], s97 offen
    s_cmp_lg_u32 s2, 0
    s_cbranch_scc1 L_fin0
    s_add_u32 s50, s100, 1
    v_mov_b32 v20, s50
    v_mov_b32 v21, 0
    s_mov_b64 exec, 1
    buffer_store_dword v20, v21, s[36:39], 0 offen sc1
L_fin0:
    s_mov_b64 exec, -1
L_fin:
L_end:
    s_endpgm
.section .rodata,"a"
.p2align 6
.amdhsa_kernel recurrent_scan__gqa_block_cached__glu_gated_swiglu__decode_kernel
  .amdhsa_next_free_vgpr 256
  .amdhsa_next_free_sgpr 102
  .amdhsa_accum_offset 256
  .amdhsa_group_segment_fixed_size 0
  .amdhsa_kernarg_size 96
  .amdhsa_user_sgpr_count 2
  .amdhsa_user_sgpr_kernarg_segment_ptr 1
  .amdhsa_system_sgpr_workgroup_id_x 1
.end_amdhsa_kernel
```
